```python
import torch

def _softmax(x, axis=-1):
    return torch.softmax(x, dim=axis)
def _gelu(x):
    return torch.nn.functional.gelu(x, approximate="tanh")
def _silu(x):
    return torch.nn.functional.silu(x)
def _sigmoid(x):
    return torch.sigmoid(x)
def _layernorm(x, axis=-1, eps=1e-5):
    m = x.mean(dim=axis, keepdim=True)
    v = x.var(dim=axis, keepdim=True, unbiased=False)
    return (x - m) / torch.sqrt(v + eps)
def _scatter_add(tgt, idx, src, axis=0):
    return tgt.clone().index_add_(axis, idx, src)
def _segment_sum(src, seg, n):
    out = torch.zeros((n,) + src.shape[1:], dtype=src.dtype)
    return out.index_add_(0, seg, src)
def _pad(x, pw):
    flat = tuple(v for pair in reversed(pw) for v in pair)
    return torch.nn.functional.pad(x, flat)

kernel_name = 'parallel_sum__compressed_kv_cla__dense_activation_gelu__decode'

def setup_inputs():

    _w = (lambda a: (lambda t: t.to(torch.bfloat16) if t.is_floating_point() else t)(torch.as_tensor(a)))
    def _A_setup():
        B, H, Sq, Sk, D, M = 2, 16, 1, 4096, 256, 448
        Dc = 4 * D
        return {
            "x": _w((lambda *s: torch.randn(*s, dtype=torch.bfloat16) * 0.05)(B, Sq, M)),
            "c_kv": _w((lambda *s: torch.randn(*s, dtype=torch.bfloat16) * 0.8)(B, Sk, Dc)),
            "w_q": _w((lambda *s: torch.randn(*s, dtype=torch.bfloat16) * 3.2)(M, H, D) * (M ** -0.5)),
            "w_uk": _w((lambda *s: torch.randn(*s, dtype=torch.bfloat16) * 3.2)(Dc, H, D) * (Dc ** -0.5)),
            "w_uv": _w((lambda *s: torch.randn(*s, dtype=torch.bfloat16) * 0.8)(Dc, H, D) * (Dc ** -0.5)),
            "w_o": _w((lambda *s: torch.randn(*s, dtype=torch.bfloat16) * 0.8)(H, D, M) * ((H * D) ** -0.5)),
        }
    _A_in = _A_setup()

    def _B_setup():
        B, S, D, F = 2, 1, 448, 1792
        return {
            "x": _w((lambda *s: torch.randn(*s, dtype=torch.bfloat16) * 0.05)(B, S, D)),
            "w1": _w((lambda *s: torch.randn(*s, dtype=torch.bfloat16) * 1.6)(D, F) * (D ** -0.5)),
            "b1": _w((lambda *s: torch.randn(*s, dtype=torch.bfloat16) * 1.6)(F) * 0.01),
            "w2": _w((lambda *s: torch.randn(*s, dtype=torch.bfloat16) * 0.2)(F, D) * (F ** -0.5)),
            "b2": _w((lambda *s: torch.randn(*s, dtype=torch.bfloat16) * 0.2)(D) * 0.01),
        }
    _B_in = _B_setup()

    return {
        "A_x": _A_in["x"],
        "A_c_kv": _A_in["c_kv"],
        "A_w_q": _A_in["w_q"],
        "A_w_uk": _A_in["w_uk"],
        "A_w_uv": _A_in["w_uv"],
        "A_w_o": _A_in["w_o"],
        "B_x": _B_in["x"],
        "B_w1": _B_in["w1"],
        "B_b1": _B_in["b1"],
        "B_w2": _B_in["w2"],
        "B_b2": _B_in["b2"],
    }

def reference(A_x, A_c_kv, A_w_q, A_w_uk, A_w_uv, A_w_o, B_x, B_w1, B_b1, B_w2, B_b2):
    def _A_ref(x, c_kv, w_q, w_uk, w_uv, w_o):
        B, Sq, M = x.shape[0], x.shape[1], x.shape[2]
        Sk = c_kv.shape[1]
        H, D = w_q.shape[1], w_q.shape[2]
        q = torch.einsum("bqm,mhd->bhqd", x, w_q)
        k = torch.einsum("bkc,chd->bhkd", c_kv, w_uk)
        v = torch.einsum("bkc,chd->bhkd", c_kv, w_uv)
        scores = torch.einsum("bhqd,bhkd->bhqk", q, k) * (D ** -0.5)
        off = Sk - Sq
        qi = torch.arange(Sq)[:, None]
        kj = torch.arange(Sk)[None, :]
        cmask = kj <= (qi + off)
        scores = torch.where(cmask[None, None], scores, -1e9)
        p = _softmax(scores, axis=-1)
        ctx = torch.einsum("bhqk,bhkd->bhqd", p, v)
        return torch.einsum("bhqd,hdm->bqm", ctx, w_o)

    def _B_ref(x, w1, b1, w2, b2):
        h = torch.einsum("bsd,df->bsf", x, w1) + b1
        h = _gelu(h)
        return torch.einsum("bsf,fd->bsd", h, w2) + b2

    x = A_x
    xn = _layernorm(x, axis=-1)
    return x + _A_ref(xn, A_c_kv, A_w_q, A_w_uk, A_w_uv, A_w_o) + _B_ref(xn, B_w1, B_b1, B_w2, B_b2)
```

```asm
; @launch kernel=k1_kernel grid=(92,1,1) block=(256,1,1) lds=20480
; @launch kernel=k2_kernel grid=(256,1,1) block=(256,1,1) lds=0
; @launch kernel=k3_kernel grid=(256,1,1) block=(256,1,1) lds=75264
; @launch kernel=k4_kernel grid=(256,1,1) block=(256,1,1) lds=18432
; @launch kernel=k5_kernel grid=(184,1,1) block=(256,1,1) lds=16384
.amdgcn_target "amdgcn-amd-amdhsa--gfx950"
.text
.macro DPPRED op, v, bc
  s_nop 1
  \op \v, \v, \v row_shr:1 row_mask:0xf bank_mask:0xf \bc
  s_nop 1
  \op \v, \v, \v row_shr:2 row_mask:0xf bank_mask:0xf \bc
  s_nop 1
  \op \v, \v, \v row_shr:4 row_mask:0xf bank_mask:0xf \bc
  s_nop 1
  \op \v, \v, \v row_shr:8 row_mask:0xf bank_mask:0xf \bc
  s_nop 1
  \op \v, \v, \v row_bcast:15 row_mask:0xa bank_mask:0xf
  s_nop 1
  \op \v, \v, \v row_bcast:31 row_mask:0xc bank_mask:0xf
  s_nop 1
.endm
.globl k1_kernel
.p2align 8
.type k1_kernel,@function
k1_kernel:

  s_cmp_ge_u32 s2, 92
  s_cbranch_scc1 k1_end
  s_load_dwordx2 s[4:5], s[0:1], 0
  s_load_dwordx2 s[6:7], s[0:1], 16
  s_load_dwordx2 s[8:9], s[0:1], 56
  s_load_dwordx2 s[10:11], s[0:1], 64
  s_load_dwordx2 s[12:13], s[0:1], 104
  v_lshrrev_b32 v1, 6, v0
  v_and_b32 v2, 63, v0
  v_readfirstlane_b32 s14, v1
  s_waitcnt lgkmcnt(0)
  s_sub_u32 s20, s2, 64
  s_cmp_lt_u32 s2, 64
  s_cselect_b32 s16, s6, s8
  s_cselect_b32 s17, s7, s9
  s_movk_i32 s18, 3584
  s_cselect_b32 s18, 8192, s18
  s_cselect_b32 s19, s2, s20
  s_lshl_b32 s19, s19, 7
  v_lshrrev_b32 v3, 3, v2
  s_mul_i32 s21, s14, 112
  v_add_u32 v3, s21, v3
  v_mul_lo_u32 v4, v3, s18
  v_and_b32 v5, 7, v2
  v_lshlrev_b32 v5, 4, v5
  v_add3_u32 v4, v4, v5, s19
  s_lshl_b32 s22, s18, 3

  global_load_dwordx4 v[16:19], v4, s[16:17] nt
  v_add_u32 v4, s22, v4
  global_load_dwordx4 v[20:23], v4, s[16:17] nt
  v_add_u32 v4, s22, v4
  global_load_dwordx4 v[24:27], v4, s[16:17] nt
  v_add_u32 v4, s22, v4
  global_load_dwordx4 v[28:31], v4, s[16:17] nt
  v_add_u32 v4, s22, v4
  global_load_dwordx4 v[32:35], v4, s[16:17] nt
  v_add_u32 v4, s22, v4
  global_load_dwordx4 v[36:39], v4, s[16:17] nt
  v_add_u32 v4, s22, v4
  global_load_dwordx4 v[40:43], v4, s[16:17] nt
  v_add_u32 v4, s22, v4
  global_load_dwordx4 v[44:47], v4, s[16:17] nt
  v_add_u32 v4, s22, v4
  global_load_dwordx4 v[48:51], v4, s[16:17] nt
  v_add_u32 v4, s22, v4
  global_load_dwordx4 v[52:55], v4, s[16:17] nt
  v_add_u32 v4, s22, v4
  global_load_dwordx4 v[56:59], v4, s[16:17] nt
  v_add_u32 v4, s22, v4
  global_load_dwordx4 v[60:63], v4, s[16:17] nt
  v_add_u32 v4, s22, v4
  global_load_dwordx4 v[64:67], v4, s[16:17] nt
  v_add_u32 v4, s22, v4
  global_load_dwordx4 v[68:71], v4, s[16:17] nt

  s_cmp_ge_u32 s2, 8
  s_cbranch_scc1 k1_nozero
  v_cmp_gt_u32 vcc, 224, v0
  s_and_saveexec_b64 s[24:25], vcc
  s_cbranch_execz k1_z2
  v_mov_b32 v8, 0
  v_mov_b32 v9, 0
  v_mov_b32 v10, 0
  v_mov_b32 v11, 0
  s_mul_i32 s23, s2, 3584
  s_add_u32 s23, s23, 131072
  v_lshlrev_b32 v6, 4, v0
  v_add_u32 v6, s23, v6
  global_store_dwordx4 v6, v[8:11], s[12:13]
k1_z2:
  s_mov_b64 exec, s[24:25]
k1_nozero:
  s_cmp_ge_u32 s14, 2
  s_cbranch_scc1 k1_noln
  v_mov_b32 v8, 0
  v_mov_b32 v9, 0
  v_mov_b32 v10, 0
  v_mov_b32 v11, 0
  s_mul_i32 s23, s14, 896
  v_lshlrev_b32 v6, 4, v2
  v_add_u32 v6, s23, v6
  v_cmp_gt_u32 vcc, 56, v2
  s_and_saveexec_b64 s[24:25], vcc
  global_load_dwordx4 v[8:11], v6, s[4:5]
  s_mov_b64 exec, s[24:25]
  s_waitcnt vmcnt(0)

  v_lshlrev_b32 v80, 16, v8
  v_and_b32 v81, 0xffff0000, v8
  v_lshlrev_b32 v82, 16, v9
  v_and_b32 v83, 0xffff0000, v9
  v_lshlrev_b32 v84, 16, v10
  v_and_b32 v85, 0xffff0000, v10
  v_lshlrev_b32 v86, 16, v11
  v_and_b32 v87, 0xffff0000, v11
  v_add_f32 v12, v80, v81
  v_add_f32 v12, v12, v82
  v_add_f32 v12, v12, v83
  v_add_f32 v12, v12, v84
  v_add_f32 v12, v12, v85
  v_add_f32 v12, v12, v86
  v_add_f32 v12, v12, v87
  DPPRED v_add_f32_dpp, v12, bound_ctrl:0
  v_readlane_b32 s26, v12, 63
  s_nop 1
  v_mov_b32 v13, 0x3b124925
  v_mul_f32 v13, s26, v13
  v_mov_b32 v12, 0

  v_sub_f32 v14, v80, v13
  v_fmac_f32 v12, v14, v14
  v_sub_f32 v14, v81, v13
  v_fmac_f32 v12, v14, v14
  v_sub_f32 v14, v82, v13
  v_fmac_f32 v12, v14, v14
  v_sub_f32 v14, v83, v13
  v_fmac_f32 v12, v14, v14
  v_sub_f32 v14, v84, v13
  v_fmac_f32 v12, v14, v14
  v_sub_f32 v14, v85, v13
  v_fmac_f32 v12, v14, v14
  v_sub_f32 v14, v86, v13
  v_fmac_f32 v12, v14, v14
  v_sub_f32 v14, v87, v13
  v_fmac_f32 v12, v14, v14
  v_cndmask_b32 v12, 0, v12, vcc
  DPPRED v_add_f32_dpp, v12, bound_ctrl:0
  v_readlane_b32 s27, v12, 63
  s_nop 1
  v_mov_b32 v14, 0x3b124925
  v_mul_f32 v14, s27, v14
  v_cvt_pk_bf16_f32 v13, v13, v14
  v_and_b32 v14, 0xffff0000, v13
  v_lshlrev_b32 v13, 16, v13
  v_add_f32 v14, 0x3727c5ac, v14
  v_cvt_pk_bf16_f32 v14, v14, v14
  v_lshlrev_b32 v14, 16, v14
  v_sqrt_f32 v14, v14
  s_nop 0
  v_cvt_pk_bf16_f32 v14, v14, v14
  v_lshlrev_b32 v14, 16, v14
  v_rcp_f32 v15, v14
  s_nop 0

  v_sub_f32 v80, v80, v13
  v_cvt_pk_bf16_f32 v80, v80, v80
  v_lshlrev_b32 v80, 16, v80
  v_mul_f32 v7, v80, v15
  v_fma_f32 v6, -v7, v14, v80
  v_fma_f32 v7, v6, v15, v7
  v_cvt_pk_bf16_f32 v7, v7, v7
  v_lshlrev_b32 v80, 16, v7
  v_sub_f32 v81, v81, v13
  v_cvt_pk_bf16_f32 v81, v81, v81
  v_lshlrev_b32 v81, 16, v81
  v_mul_f32 v7, v81, v15
  v_fma_f32 v6, -v7, v14, v81
  v_fma_f32 v7, v6, v15, v7
  v_cvt_pk_bf16_f32 v7, v7, v7
  v_lshlrev_b32 v81, 16, v7
  v_sub_f32 v82, v82, v13
  v_cvt_pk_bf16_f32 v82, v82, v82
  v_lshlrev_b32 v82, 16, v82
  v_mul_f32 v7, v82, v15
  v_fma_f32 v6, -v7, v14, v82
  v_fma_f32 v7, v6, v15, v7
  v_cvt_pk_bf16_f32 v7, v7, v7
  v_lshlrev_b32 v82, 16, v7
  v_sub_f32 v83, v83, v13
  v_cvt_pk_bf16_f32 v83, v83, v83
  v_lshlrev_b32 v83, 16, v83
  v_mul_f32 v7, v83, v15
  v_fma_f32 v6, -v7, v14, v83
  v_fma_f32 v7, v6, v15, v7
  v_cvt_pk_bf16_f32 v7, v7, v7
  v_lshlrev_b32 v83, 16, v7
  v_sub_f32 v84, v84, v13
  v_cvt_pk_bf16_f32 v84, v84, v84
  v_lshlrev_b32 v84, 16, v84
  v_mul_f32 v7, v84, v15
  v_fma_f32 v6, -v7, v14, v84
  v_fma_f32 v7, v6, v15, v7
  v_cvt_pk_bf16_f32 v7, v7, v7
  v_lshlrev_b32 v84, 16, v7
  v_sub_f32 v85, v85, v13
  v_cvt_pk_bf16_f32 v85, v85, v85
  v_lshlrev_b32 v85, 16, v85
  v_mul_f32 v7, v85, v15
  v_fma_f32 v6, -v7, v14, v85
  v_fma_f32 v7, v6, v15, v7
  v_cvt_pk_bf16_f32 v7, v7, v7
  v_lshlrev_b32 v85, 16, v7
  v_sub_f32 v86, v86, v13
  v_cvt_pk_bf16_f32 v86, v86, v86
  v_lshlrev_b32 v86, 16, v86
  v_mul_f32 v7, v86, v15
  v_fma_f32 v6, -v7, v14, v86
  v_fma_f32 v7, v6, v15, v7
  v_cvt_pk_bf16_f32 v7, v7, v7
  v_lshlrev_b32 v86, 16, v7
  v_sub_f32 v87, v87, v13
  v_cvt_pk_bf16_f32 v87, v87, v87
  v_lshlrev_b32 v87, 16, v87
  v_mul_f32 v7, v87, v15
  v_fma_f32 v6, -v7, v14, v87
  v_fma_f32 v7, v6, v15, v7
  v_cvt_pk_bf16_f32 v7, v7, v7
  v_lshlrev_b32 v87, 16, v7
  v_lshlrev_b32 v6, 6, v2
  s_lshl_b32 s23, s14, 2
  v_add_u32 v6, s23, v6
  s_and_saveexec_b64 s[24:25], vcc

  ds_write_b32 v6, v80 offset:0
  ds_write_b32 v6, v81 offset:8
  ds_write_b32 v6, v82 offset:16
  ds_write_b32 v6, v83 offset:24
  ds_write_b32 v6, v84 offset:32
  ds_write_b32 v6, v85 offset:40
  ds_write_b32 v6, v86 offset:48
  ds_write_b32 v6, v87 offset:56
  s_mov_b64 exec, s[24:25]
k1_noln:
  s_waitcnt lgkmcnt(0)
  s_barrier
  v_lshlrev_b32 v6, 3, v3

  ds_read_b64 v[80:81], v6 offset:0
  ds_read_b64 v[82:83], v6 offset:64
  ds_read_b64 v[84:85], v6 offset:128
  ds_read_b64 v[86:87], v6 offset:192
  ds_read_b64 v[88:89], v6 offset:256
  ds_read_b64 v[90:91], v6 offset:320
  ds_read_b64 v[92:93], v6 offset:384
  ds_read_b64 v[94:95], v6 offset:448
  ds_read_b64 v[96:97], v6 offset:512
  ds_read_b64 v[98:99], v6 offset:576
  ds_read_b64 v[100:101], v6 offset:640
  ds_read_b64 v[102:103], v6 offset:704
  ds_read_b64 v[104:105], v6 offset:768
  ds_read_b64 v[106:107], v6 offset:832
  v_mov_b32 v112, 0
  v_mov_b32 v113, 0
  v_mov_b32 v114, 0
  v_mov_b32 v115, 0
  v_mov_b32 v116, 0
  v_mov_b32 v117, 0
  v_mov_b32 v118, 0
  v_mov_b32 v119, 0
  v_mov_b32 v120, 0
  v_mov_b32 v121, 0
  v_mov_b32 v122, 0
  v_mov_b32 v123, 0
  v_mov_b32 v124, 0
  v_mov_b32 v125, 0
  v_mov_b32 v126, 0
  v_mov_b32 v127, 0
  s_waitcnt vmcnt(0) lgkmcnt(0)
  v_lshlrev_b32 v8, 16, v16
  v_and_b32 v9, 0xffff0000, v16
  v_fmac_f32 v112, v80, v8
  v_fmac_f32 v113, v80, v9
  v_fmac_f32 v120, v81, v8
  v_fmac_f32 v121, v81, v9
  v_lshlrev_b32 v8, 16, v17
  v_and_b32 v9, 0xffff0000, v17
  v_fmac_f32 v114, v80, v8
  v_fmac_f32 v115, v80, v9
  v_fmac_f32 v122, v81, v8
  v_fmac_f32 v123, v81, v9
  v_lshlrev_b32 v8, 16, v18
  v_and_b32 v9, 0xffff0000, v18
  v_fmac_f32 v116, v80, v8
  v_fmac_f32 v117, v80, v9
  v_fmac_f32 v124, v81, v8
  v_fmac_f32 v125, v81, v9
  v_lshlrev_b32 v8, 16, v19
  v_and_b32 v9, 0xffff0000, v19
  v_fmac_f32 v118, v80, v8
  v_fmac_f32 v119, v80, v9
  v_fmac_f32 v126, v81, v8
  v_fmac_f32 v127, v81, v9
  v_lshlrev_b32 v8, 16, v20
  v_and_b32 v9, 0xffff0000, v20
  v_fmac_f32 v112, v82, v8
  v_fmac_f32 v113, v82, v9
  v_fmac_f32 v120, v83, v8
  v_fmac_f32 v121, v83, v9
  v_lshlrev_b32 v8, 16, v21
  v_and_b32 v9, 0xffff0000, v21
  v_fmac_f32 v114, v82, v8
  v_fmac_f32 v115, v82, v9
  v_fmac_f32 v122, v83, v8
  v_fmac_f32 v123, v83, v9
  v_lshlrev_b32 v8, 16, v22
  v_and_b32 v9, 0xffff0000, v22
  v_fmac_f32 v116, v82, v8
  v_fmac_f32 v117, v82, v9
  v_fmac_f32 v124, v83, v8
  v_fmac_f32 v125, v83, v9
  v_lshlrev_b32 v8, 16, v23
  v_and_b32 v9, 0xffff0000, v23
  v_fmac_f32 v118, v82, v8
  v_fmac_f32 v119, v82, v9
  v_fmac_f32 v126, v83, v8
  v_fmac_f32 v127, v83, v9
  v_lshlrev_b32 v8, 16, v24
  v_and_b32 v9, 0xffff0000, v24
  v_fmac_f32 v112, v84, v8
  v_fmac_f32 v113, v84, v9
  v_fmac_f32 v120, v85, v8
  v_fmac_f32 v121, v85, v9
  v_lshlrev_b32 v8, 16, v25
  v_and_b32 v9, 0xffff0000, v25
  v_fmac_f32 v114, v84, v8
  v_fmac_f32 v115, v84, v9
  v_fmac_f32 v122, v85, v8
  v_fmac_f32 v123, v85, v9
  v_lshlrev_b32 v8, 16, v26
  v_and_b32 v9, 0xffff0000, v26
  v_fmac_f32 v116, v84, v8
  v_fmac_f32 v117, v84, v9
  v_fmac_f32 v124, v85, v8
  v_fmac_f32 v125, v85, v9
  v_lshlrev_b32 v8, 16, v27
  v_and_b32 v9, 0xffff0000, v27
  v_fmac_f32 v118, v84, v8
  v_fmac_f32 v119, v84, v9
  v_fmac_f32 v126, v85, v8
  v_fmac_f32 v127, v85, v9
  v_lshlrev_b32 v8, 16, v28
  v_and_b32 v9, 0xffff0000, v28
  v_fmac_f32 v112, v86, v8
  v_fmac_f32 v113, v86, v9
  v_fmac_f32 v120, v87, v8
  v_fmac_f32 v121, v87, v9
  v_lshlrev_b32 v8, 16, v29
  v_and_b32 v9, 0xffff0000, v29
  v_fmac_f32 v114, v86, v8
  v_fmac_f32 v115, v86, v9
  v_fmac_f32 v122, v87, v8
  v_fmac_f32 v123, v87, v9
  v_lshlrev_b32 v8, 16, v30
  v_and_b32 v9, 0xffff0000, v30
  v_fmac_f32 v116, v86, v8
  v_fmac_f32 v117, v86, v9
  v_fmac_f32 v124, v87, v8
  v_fmac_f32 v125, v87, v9
  v_lshlrev_b32 v8, 16, v31
  v_and_b32 v9, 0xffff0000, v31
  v_fmac_f32 v118, v86, v8
  v_fmac_f32 v119, v86, v9
  v_fmac_f32 v126, v87, v8
  v_fmac_f32 v127, v87, v9
  v_lshlrev_b32 v8, 16, v32
  v_and_b32 v9, 0xffff0000, v32
  v_fmac_f32 v112, v88, v8
  v_fmac_f32 v113, v88, v9
  v_fmac_f32 v120, v89, v8
  v_fmac_f32 v121, v89, v9
  v_lshlrev_b32 v8, 16, v33
  v_and_b32 v9, 0xffff0000, v33
  v_fmac_f32 v114, v88, v8
  v_fmac_f32 v115, v88, v9
  v_fmac_f32 v122, v89, v8
  v_fmac_f32 v123, v89, v9
  v_lshlrev_b32 v8, 16, v34
  v_and_b32 v9, 0xffff0000, v34
  v_fmac_f32 v116, v88, v8
  v_fmac_f32 v117, v88, v9
  v_fmac_f32 v124, v89, v8
  v_fmac_f32 v125, v89, v9
  v_lshlrev_b32 v8, 16, v35
  v_and_b32 v9, 0xffff0000, v35
  v_fmac_f32 v118, v88, v8
  v_fmac_f32 v119, v88, v9
  v_fmac_f32 v126, v89, v8
  v_fmac_f32 v127, v89, v9
  v_lshlrev_b32 v8, 16, v36
  v_and_b32 v9, 0xffff0000, v36
  v_fmac_f32 v112, v90, v8
  v_fmac_f32 v113, v90, v9
  v_fmac_f32 v120, v91, v8
  v_fmac_f32 v121, v91, v9
  v_lshlrev_b32 v8, 16, v37
  v_and_b32 v9, 0xffff0000, v37
  v_fmac_f32 v114, v90, v8
  v_fmac_f32 v115, v90, v9
  v_fmac_f32 v122, v91, v8
  v_fmac_f32 v123, v91, v9
  v_lshlrev_b32 v8, 16, v38
  v_and_b32 v9, 0xffff0000, v38
  v_fmac_f32 v116, v90, v8
  v_fmac_f32 v117, v90, v9
  v_fmac_f32 v124, v91, v8
  v_fmac_f32 v125, v91, v9
  v_lshlrev_b32 v8, 16, v39
  v_and_b32 v9, 0xffff0000, v39
  v_fmac_f32 v118, v90, v8
  v_fmac_f32 v119, v90, v9
  v_fmac_f32 v126, v91, v8
  v_fmac_f32 v127, v91, v9
  v_lshlrev_b32 v8, 16, v40
  v_and_b32 v9, 0xffff0000, v40
  v_fmac_f32 v112, v92, v8
  v_fmac_f32 v113, v92, v9
  v_fmac_f32 v120, v93, v8
  v_fmac_f32 v121, v93, v9
  v_lshlrev_b32 v8, 16, v41
  v_and_b32 v9, 0xffff0000, v41
  v_fmac_f32 v114, v92, v8
  v_fmac_f32 v115, v92, v9
  v_fmac_f32 v122, v93, v8
  v_fmac_f32 v123, v93, v9
  v_lshlrev_b32 v8, 16, v42
  v_and_b32 v9, 0xffff0000, v42
  v_fmac_f32 v116, v92, v8
  v_fmac_f32 v117, v92, v9
  v_fmac_f32 v124, v93, v8
  v_fmac_f32 v125, v93, v9
  v_lshlrev_b32 v8, 16, v43
  v_and_b32 v9, 0xffff0000, v43
  v_fmac_f32 v118, v92, v8
  v_fmac_f32 v119, v92, v9
  v_fmac_f32 v126, v93, v8
  v_fmac_f32 v127, v93, v9
  v_lshlrev_b32 v8, 16, v44
  v_and_b32 v9, 0xffff0000, v44
  v_fmac_f32 v112, v94, v8
  v_fmac_f32 v113, v94, v9
  v_fmac_f32 v120, v95, v8
  v_fmac_f32 v121, v95, v9
  v_lshlrev_b32 v8, 16, v45
  v_and_b32 v9, 0xffff0000, v45
  v_fmac_f32 v114, v94, v8
  v_fmac_f32 v115, v94, v9
  v_fmac_f32 v122, v95, v8
  v_fmac_f32 v123, v95, v9
  v_lshlrev_b32 v8, 16, v46
  v_and_b32 v9, 0xffff0000, v46
  v_fmac_f32 v116, v94, v8
  v_fmac_f32 v117, v94, v9
  v_fmac_f32 v124, v95, v8
  v_fmac_f32 v125, v95, v9
  v_lshlrev_b32 v8, 16, v47
  v_and_b32 v9, 0xffff0000, v47
  v_fmac_f32 v118, v94, v8
  v_fmac_f32 v119, v94, v9
  v_fmac_f32 v126, v95, v8
  v_fmac_f32 v127, v95, v9
  v_lshlrev_b32 v8, 16, v48
  v_and_b32 v9, 0xffff0000, v48
  v_fmac_f32 v112, v96, v8
  v_fmac_f32 v113, v96, v9
  v_fmac_f32 v120, v97, v8
  v_fmac_f32 v121, v97, v9
  v_lshlrev_b32 v8, 16, v49
  v_and_b32 v9, 0xffff0000, v49
  v_fmac_f32 v114, v96, v8
  v_fmac_f32 v115, v96, v9
  v_fmac_f32 v122, v97, v8
  v_fmac_f32 v123, v97, v9
  v_lshlrev_b32 v8, 16, v50
  v_and_b32 v9, 0xffff0000, v50
  v_fmac_f32 v116, v96, v8
  v_fmac_f32 v117, v96, v9
  v_fmac_f32 v124, v97, v8
  v_fmac_f32 v125, v97, v9
  v_lshlrev_b32 v8, 16, v51
  v_and_b32 v9, 0xffff0000, v51
  v_fmac_f32 v118, v96, v8
  v_fmac_f32 v119, v96, v9
  v_fmac_f32 v126, v97, v8
  v_fmac_f32 v127, v97, v9
  v_lshlrev_b32 v8, 16, v52
  v_and_b32 v9, 0xffff0000, v52
  v_fmac_f32 v112, v98, v8
  v_fmac_f32 v113, v98, v9
  v_fmac_f32 v120, v99, v8
  v_fmac_f32 v121, v99, v9
  v_lshlrev_b32 v8, 16, v53
  v_and_b32 v9, 0xffff0000, v53
  v_fmac_f32 v114, v98, v8
  v_fmac_f32 v115, v98, v9
  v_fmac_f32 v122, v99, v8
  v_fmac_f32 v123, v99, v9
  v_lshlrev_b32 v8, 16, v54
  v_and_b32 v9, 0xffff0000, v54
  v_fmac_f32 v116, v98, v8
  v_fmac_f32 v117, v98, v9
  v_fmac_f32 v124, v99, v8
  v_fmac_f32 v125, v99, v9
  v_lshlrev_b32 v8, 16, v55
  v_and_b32 v9, 0xffff0000, v55
  v_fmac_f32 v118, v98, v8
  v_fmac_f32 v119, v98, v9
  v_fmac_f32 v126, v99, v8
  v_fmac_f32 v127, v99, v9
  v_lshlrev_b32 v8, 16, v56
  v_and_b32 v9, 0xffff0000, v56
  v_fmac_f32 v112, v100, v8
  v_fmac_f32 v113, v100, v9
  v_fmac_f32 v120, v101, v8
  v_fmac_f32 v121, v101, v9
  v_lshlrev_b32 v8, 16, v57
  v_and_b32 v9, 0xffff0000, v57
  v_fmac_f32 v114, v100, v8
  v_fmac_f32 v115, v100, v9
  v_fmac_f32 v122, v101, v8
  v_fmac_f32 v123, v101, v9
  v_lshlrev_b32 v8, 16, v58
  v_and_b32 v9, 0xffff0000, v58
  v_fmac_f32 v116, v100, v8
  v_fmac_f32 v117, v100, v9
  v_fmac_f32 v124, v101, v8
  v_fmac_f32 v125, v101, v9
  v_lshlrev_b32 v8, 16, v59
  v_and_b32 v9, 0xffff0000, v59
  v_fmac_f32 v118, v100, v8
  v_fmac_f32 v119, v100, v9
  v_fmac_f32 v126, v101, v8
  v_fmac_f32 v127, v101, v9
  v_lshlrev_b32 v8, 16, v60
  v_and_b32 v9, 0xffff0000, v60
  v_fmac_f32 v112, v102, v8
  v_fmac_f32 v113, v102, v9
  v_fmac_f32 v120, v103, v8
  v_fmac_f32 v121, v103, v9
  v_lshlrev_b32 v8, 16, v61
  v_and_b32 v9, 0xffff0000, v61
  v_fmac_f32 v114, v102, v8
  v_fmac_f32 v115, v102, v9
  v_fmac_f32 v122, v103, v8
  v_fmac_f32 v123, v103, v9
  v_lshlrev_b32 v8, 16, v62
  v_and_b32 v9, 0xffff0000, v62
  v_fmac_f32 v116, v102, v8
  v_fmac_f32 v117, v102, v9
  v_fmac_f32 v124, v103, v8
  v_fmac_f32 v125, v103, v9
  v_lshlrev_b32 v8, 16, v63
  v_and_b32 v9, 0xffff0000, v63
  v_fmac_f32 v118, v102, v8
  v_fmac_f32 v119, v102, v9
  v_fmac_f32 v126, v103, v8
  v_fmac_f32 v127, v103, v9
  v_lshlrev_b32 v8, 16, v64
  v_and_b32 v9, 0xffff0000, v64
  v_fmac_f32 v112, v104, v8
  v_fmac_f32 v113, v104, v9
  v_fmac_f32 v120, v105, v8
  v_fmac_f32 v121, v105, v9
  v_lshlrev_b32 v8, 16, v65
  v_and_b32 v9, 0xffff0000, v65
  v_fmac_f32 v114, v104, v8
  v_fmac_f32 v115, v104, v9
  v_fmac_f32 v122, v105, v8
  v_fmac_f32 v123, v105, v9
  v_lshlrev_b32 v8, 16, v66
  v_and_b32 v9, 0xffff0000, v66
  v_fmac_f32 v116, v104, v8
  v_fmac_f32 v117, v104, v9
  v_fmac_f32 v124, v105, v8
  v_fmac_f32 v125, v105, v9
  v_lshlrev_b32 v8, 16, v67
  v_and_b32 v9, 0xffff0000, v67
  v_fmac_f32 v118, v104, v8
  v_fmac_f32 v119, v104, v9
  v_fmac_f32 v126, v105, v8
  v_fmac_f32 v127, v105, v9
  v_lshlrev_b32 v8, 16, v68
  v_and_b32 v9, 0xffff0000, v68
  v_fmac_f32 v112, v106, v8
  v_fmac_f32 v113, v106, v9
  v_fmac_f32 v120, v107, v8
  v_fmac_f32 v121, v107, v9
  v_lshlrev_b32 v8, 16, v69
  v_and_b32 v9, 0xffff0000, v69
  v_fmac_f32 v114, v106, v8
  v_fmac_f32 v115, v106, v9
  v_fmac_f32 v122, v107, v8
  v_fmac_f32 v123, v107, v9
  v_lshlrev_b32 v8, 16, v70
  v_and_b32 v9, 0xffff0000, v70
  v_fmac_f32 v116, v106, v8
  v_fmac_f32 v117, v106, v9
  v_fmac_f32 v124, v107, v8
  v_fmac_f32 v125, v107, v9
  v_lshlrev_b32 v8, 16, v71
  v_and_b32 v9, 0xffff0000, v71
  v_fmac_f32 v118, v106, v8
  v_fmac_f32 v119, v106, v9
  v_fmac_f32 v126, v107, v8
  v_fmac_f32 v127, v107, v9
  v_lshrrev_b32 v6, 3, v0
  v_lshlrev_b32 v6, 9, v6
  v_and_b32 v7, 7, v0
  v_lshlrev_b32 v7, 5, v7
  v_add_u32 v6, v6, v7
  ds_write_b128 v6, v[112:115] offset:4096
  ds_write_b128 v6, v[116:119] offset:4112
  ds_write_b128 v6, v[120:123] offset:4352
  ds_write_b128 v6, v[124:127] offset:4368
  s_waitcnt lgkmcnt(0)
  s_barrier
  v_cmp_gt_u32 vcc, 128, v0
  s_and_saveexec_b64 s[24:25], vcc
  s_cbranch_execz k1_end
  v_lshrrev_b32 v6, 6, v0
  v_and_b32 v7, 63, v0
  v_lshlrev_b32 v8, 8, v6
  v_lshl_add_u32 v8, v7, 2, v8

  ds_read_b32 v16, v8 offset:4096
  ds_read_b32 v17, v8 offset:4608
  ds_read_b32 v18, v8 offset:5120
  ds_read_b32 v19, v8 offset:5632
  ds_read_b32 v20, v8 offset:6144
  ds_read_b32 v21, v8 offset:6656
  ds_read_b32 v22, v8 offset:7168
  ds_read_b32 v23, v8 offset:7680
  ds_read_b32 v24, v8 offset:8192
  ds_read_b32 v25, v8 offset:8704
  ds_read_b32 v26, v8 offset:9216
  ds_read_b32 v27, v8 offset:9728
  ds_read_b32 v28, v8 offset:10240
  ds_read_b32 v29, v8 offset:10752
  ds_read_b32 v30, v8 offset:11264
  ds_read_b32 v31, v8 offset:11776
  ds_read_b32 v32, v8 offset:12288
  ds_read_b32 v33, v8 offset:12800
  ds_read_b32 v34, v8 offset:13312
  ds_read_b32 v35, v8 offset:13824
  ds_read_b32 v36, v8 offset:14336
  ds_read_b32 v37, v8 offset:14848
  ds_read_b32 v38, v8 offset:15360
  ds_read_b32 v39, v8 offset:15872
  ds_read_b32 v40, v8 offset:16384
  ds_read_b32 v41, v8 offset:16896
  ds_read_b32 v42, v8 offset:17408
  ds_read_b32 v43, v8 offset:17920
  ds_read_b32 v44, v8 offset:18432
  ds_read_b32 v45, v8 offset:18944
  ds_read_b32 v46, v8 offset:19456
  ds_read_b32 v47, v8 offset:19968
  s_waitcnt lgkmcnt(0)
  v_add_f32 v16, v16, v17
  v_add_f32 v16, v16, v18
  v_add_f32 v16, v16, v19
  v_add_f32 v16, v16, v20
  v_add_f32 v16, v16, v21
  v_add_f32 v16, v16, v22
  v_add_f32 v16, v16, v23
  v_add_f32 v16, v16, v24
  v_add_f32 v16, v16, v25
  v_add_f32 v16, v16, v26
  v_add_f32 v16, v16, v27
  v_add_f32 v16, v16, v28
  v_add_f32 v16, v16, v29
  v_add_f32 v16, v16, v30
  v_add_f32 v16, v16, v31
  v_add_f32 v16, v16, v32
  v_add_f32 v16, v16, v33
  v_add_f32 v16, v16, v34
  v_add_f32 v16, v16, v35
  v_add_f32 v16, v16, v36
  v_add_f32 v16, v16, v37
  v_add_f32 v16, v16, v38
  v_add_f32 v16, v16, v39
  v_add_f32 v16, v16, v40
  v_add_f32 v16, v16, v41
  v_add_f32 v16, v16, v42
  v_add_f32 v16, v16, v43
  v_add_f32 v16, v16, v44
  v_add_f32 v16, v16, v45
  v_add_f32 v16, v16, v46
  v_add_f32 v16, v16, v47
  v_cvt_pk_bf16_f32 v16, v16, v16
  s_cmp_lt_u32 s2, 64
  s_cbranch_scc0 k1_mlp
  s_lshl_b32 s23, s2, 7
  v_lshlrev_b32 v8, 13, v6
  v_lshl_add_u32 v8, v7, 1, v8
  v_add_u32 v8, s23, v8
  global_store_short v8, v16, s[12:13]
  s_branch k1_end
k1_mlp:
  s_lshl_b32 s23, s20, 7
  v_lshl_add_u32 v8, v7, 1, s23
  global_load_ushort v17, v8, s[10:11]
  v_lshlrev_b32 v16, 16, v16
  s_waitcnt vmcnt(0)
  v_lshlrev_b32 v17, 16, v17
  v_add_f32 v16, v16, v17
  v_cvt_pk_bf16_f32 v16, v16, v16
  v_lshlrev_b32 v16, 16, v16
  v_mul_f32 v17, v16, v16
  v_mov_b32 v18, 0x3d372713
  v_fma_f32 v17, v17, v18, 1.0
  v_mul_f32 v17, v17, v16
  v_mul_f32 v17, 0x40135761, v17
  v_exp_f32 v17, v17
  s_nop 0
  v_add_f32 v17, 1.0, v17
  v_rcp_f32 v17, v17
  s_nop 0
  v_fma_f32 v16, -v16, v17, v16
  v_cvt_pk_bf16_f32 v16, v16, v16
  v_lshlrev_b32 v16, 16, v16
  s_lshl_b32 s23, s20, 8
  s_add_u32 s23, s23, 65536
  v_mul_u32_u24 v8, 7168, v6
  v_lshl_add_u32 v8, v7, 2, v8
  v_add_u32 v8, s23, v8
  global_store_dword v8, v16, s[12:13]
k1_end:
  s_endpgm

.globl k2_kernel
.p2align 8
.type k2_kernel,@function
k2_kernel:

  s_cmp_ge_u32 s2, 256
  s_cbranch_scc1 k2_end
  s_load_dwordx2 s[4:5], s[0:1], 24
  s_load_dwordx2 s[12:13], s[0:1], 104
  s_lshr_b32 s14, s2, 4
  s_and_b32 s15, s2, 15
  v_lshrrev_b32 v1, 6, v0
  v_and_b32 v2, 15, v0
  v_bfe_u32 v3, v0, 4, 2
  s_lshl_b32 s16, s15, 6
  v_lshl_add_u32 v4, v1, 4, v2
  v_add_u32 v4, s16, v4
  v_lshlrev_b32 v5, 13, v4
  s_lshl_b32 s17, s14, 9
  v_lshl_add_u32 v5, v3, 4, v5
  v_add_u32 v5, s17, v5
  v_and_b32 v6, 1, v0
  v_lshlrev_b32 v6, 13, v6
  v_lshl_add_u32 v6, v3, 4, v6
  v_add_u32 v6, s17, v6
  s_waitcnt lgkmcnt(0)

  global_load_dwordx4 v[16:19], v5, s[4:5] offset:0 nt
  global_load_dwordx4 v[48:51], v6, s[12:13] offset:0
  global_load_dwordx4 v[20:23], v5, s[4:5] offset:64 nt
  global_load_dwordx4 v[52:55], v6, s[12:13] offset:64
  global_load_dwordx4 v[24:27], v5, s[4:5] offset:128 nt
  global_load_dwordx4 v[56:59], v6, s[12:13] offset:128
  global_load_dwordx4 v[28:31], v5, s[4:5] offset:192 nt
  global_load_dwordx4 v[60:63], v6, s[12:13] offset:192
  global_load_dwordx4 v[32:35], v5, s[4:5] offset:256 nt
  global_load_dwordx4 v[64:67], v6, s[12:13] offset:256
  global_load_dwordx4 v[36:39], v5, s[4:5] offset:320 nt
  global_load_dwordx4 v[68:71], v6, s[12:13] offset:320
  global_load_dwordx4 v[40:43], v5, s[4:5] offset:384 nt
  global_load_dwordx4 v[72:75], v6, s[12:13] offset:384
  global_load_dwordx4 v[44:47], v5, s[4:5] offset:448 nt
  global_load_dwordx4 v[76:79], v6, s[12:13] offset:448
  s_waitcnt vmcnt(14)
  v_mfma_f32_16x16x32_bf16 v[80:83], v[16:19], v[48:51], 0
  s_waitcnt vmcnt(12)
  v_mfma_f32_16x16x32_bf16 v[80:83], v[20:23], v[52:55], v[80:83]
  s_waitcnt vmcnt(10)
  v_mfma_f32_16x16x32_bf16 v[80:83], v[24:27], v[56:59], v[80:83]
  s_waitcnt vmcnt(8)
  v_mfma_f32_16x16x32_bf16 v[80:83], v[28:31], v[60:63], v[80:83]
  s_waitcnt vmcnt(6)
  v_mfma_f32_16x16x32_bf16 v[80:83], v[32:35], v[64:67], v[80:83]
  s_waitcnt vmcnt(4)
  v_mfma_f32_16x16x32_bf16 v[80:83], v[36:39], v[68:71], v[80:83]
  s_waitcnt vmcnt(2)
  v_mfma_f32_16x16x32_bf16 v[80:83], v[40:43], v[72:75], v[80:83]
  s_waitcnt vmcnt(0)
  v_mfma_f32_16x16x32_bf16 v[80:83], v[44:47], v[76:79], v[80:83]
  s_nop 7
  s_nop 3
  v_mov_b32 v7, 0x3db8aa3b
  v_mul_f32 v80, v80, v7
  v_mul_f32 v81, v81, v7
  v_mul_f32 v82, v82, v7
  v_mul_f32 v83, v83, v7
  v_cvt_pk_bf16_f32 v80, v80, v81
  v_cvt_pk_bf16_f32 v81, v82, v83
  v_lshlrev_b32 v8, 15, v2
  v_lshl_add_u32 v8, v1, 5, v8
  v_lshl_add_u32 v8, v3, 3, v8
  s_lshl_b32 s18, s14, 11
  s_lshl_b32 s19, s15, 7
  s_add_u32 s18, s18, s19
  s_add_u32 s18, s18, 196608
  v_add_u32 v8, s18, v8
  v_cmp_gt_u32 vcc, 2, v2
  s_and_saveexec_b64 s[24:25], vcc
  global_store_dwordx2 v8, v[80:81], s[12:13]
k2_end:
  s_endpgm

.globl k3_kernel
.p2align 8
.type k3_kernel,@function
k3_kernel:

  s_cmp_ge_u32 s2, 256
  s_cbranch_scc1 k3_end
  s_load_dwordx2 s[4:5], s[0:1], 8
  s_load_dwordx2 s[12:13], s[0:1], 104
  s_lshr_b32 s14, s2, 7
  s_and_b32 s15, s2, 127
  v_lshrrev_b32 v1, 6, v0
  v_and_b32 v2, 15, v0
  v_bfe_u32 v3, v0, 4, 2
  s_lshl_b32 s16, s14, 23
  s_lshl_b32 s17, s15, 16
  s_add_u32 s16, s16, s17
  v_lshlrev_b32 v4, 11, v2
  v_lshl_add_u32 v4, v1, 9, v4
  v_lshl_add_u32 v4, v3, 4, v4
  v_add_u32 v5, s16, v4
  s_lshl_b32 s17, s14, 15
  s_add_u32 s17, s17, 196608
  v_add_u32 v6, s17, v4
  s_waitcnt lgkmcnt(0)

  global_load_dwordx4 v[16:19], v5, s[4:5] offset:0 nt
  global_load_dwordx4 v[80:83], v6, s[12:13] offset:0
  global_load_dwordx4 v[20:23], v5, s[4:5] offset:64 nt
  global_load_dwordx4 v[84:87], v6, s[12:13] offset:64
  global_load_dwordx4 v[24:27], v5, s[4:5] offset:128 nt
  global_load_dwordx4 v[88:91], v6, s[12:13] offset:128
  global_load_dwordx4 v[28:31], v5, s[4:5] offset:192 nt
  global_load_dwordx4 v[92:95], v6, s[12:13] offset:192
  global_load_dwordx4 v[32:35], v5, s[4:5] offset:256 nt
  global_load_dwordx4 v[96:99], v6, s[12:13] offset:256
  global_load_dwordx4 v[36:39], v5, s[4:5] offset:320 nt
  global_load_dwordx4 v[100:103], v6, s[12:13] offset:320
  global_load_dwordx4 v[40:43], v5, s[4:5] offset:384 nt
  global_load_dwordx4 v[104:107], v6, s[12:13] offset:384
  global_load_dwordx4 v[44:47], v5, s[4:5] offset:448 nt
  global_load_dwordx4 v[108:111], v6, s[12:13] offset:448
  v_add_u32 v5, 0x8000, v5
  global_load_dwordx4 v[48:51], v5, s[4:5] offset:0 nt
  global_load_dwordx4 v[52:55], v5, s[4:5] offset:64 nt
  global_load_dwordx4 v[56:59], v5, s[4:5] offset:128 nt
  global_load_dwordx4 v[60:63], v5, s[4:5] offset:192 nt
  global_load_dwordx4 v[64:67], v5, s[4:5] offset:256 nt
  global_load_dwordx4 v[68:71], v5, s[4:5] offset:320 nt
  global_load_dwordx4 v[72:75], v5, s[4:5] offset:384 nt
  global_load_dwordx4 v[76:79], v5, s[4:5] offset:448 nt
  v_mul_u32_u24 v7, 2064, v2
  v_lshl_add_u32 v7, v1, 9, v7
  v_lshl_add_u32 v7, v3, 4, v7
  v_add_u32 v7, 9216, v7

  s_waitcnt vmcnt(22)
  v_mfma_f32_16x16x32_bf16 v[112:115], v[16:19], v[80:83], 0
  ds_write_b128 v7, v[16:19] offset:0
  s_waitcnt vmcnt(20)
  v_mfma_f32_16x16x32_bf16 v[112:115], v[20:23], v[84:87], v[112:115]
  ds_write_b128 v7, v[20:23] offset:64
  s_waitcnt vmcnt(18)
  v_mfma_f32_16x16x32_bf16 v[112:115], v[24:27], v[88:91], v[112:115]
  ds_write_b128 v7, v[24:27] offset:128
  s_waitcnt vmcnt(16)
  v_mfma_f32_16x16x32_bf16 v[112:115], v[28:31], v[92:95], v[112:115]
  ds_write_b128 v7, v[28:31] offset:192
  s_waitcnt vmcnt(14)
  v_mfma_f32_16x16x32_bf16 v[112:115], v[32:35], v[96:99], v[112:115]
  ds_write_b128 v7, v[32:35] offset:256
  s_waitcnt vmcnt(12)
  v_mfma_f32_16x16x32_bf16 v[112:115], v[36:39], v[100:103], v[112:115]
  ds_write_b128 v7, v[36:39] offset:320
  s_waitcnt vmcnt(10)
  v_mfma_f32_16x16x32_bf16 v[112:115], v[40:43], v[104:107], v[112:115]
  ds_write_b128 v7, v[40:43] offset:384
  s_waitcnt vmcnt(8)
  v_mfma_f32_16x16x32_bf16 v[112:115], v[44:47], v[108:111], v[112:115]
  ds_write_b128 v7, v[44:47] offset:448
  s_waitcnt vmcnt(7)
  v_mfma_f32_16x16x32_bf16 v[116:119], v[48:51], v[80:83], 0
  ds_write_b128 v7, v[48:51] offset:33024
  s_waitcnt vmcnt(6)
  v_mfma_f32_16x16x32_bf16 v[116:119], v[52:55], v[84:87], v[116:119]
  ds_write_b128 v7, v[52:55] offset:33088
  s_waitcnt vmcnt(5)
  v_mfma_f32_16x16x32_bf16 v[116:119], v[56:59], v[88:91], v[116:119]
  ds_write_b128 v7, v[56:59] offset:33152
  s_waitcnt vmcnt(4)
  v_mfma_f32_16x16x32_bf16 v[116:119], v[60:63], v[92:95], v[116:119]
  ds_write_b128 v7, v[60:63] offset:33216
  s_waitcnt vmcnt(3)
  v_mfma_f32_16x16x32_bf16 v[116:119], v[64:67], v[96:99], v[116:119]
  ds_write_b128 v7, v[64:67] offset:33280
  s_waitcnt vmcnt(2)
  v_mfma_f32_16x16x32_bf16 v[116:119], v[68:71], v[100:103], v[116:119]
  ds_write_b128 v7, v[68:71] offset:33344
  s_waitcnt vmcnt(1)
  v_mfma_f32_16x16x32_bf16 v[116:119], v[72:75], v[104:107], v[116:119]
  ds_write_b128 v7, v[72:75] offset:33408
  s_waitcnt vmcnt(0)
  v_mfma_f32_16x16x32_bf16 v[116:119], v[76:79], v[108:111], v[116:119]
  ds_write_b128 v7, v[76:79] offset:33472
  v_mul_u32_u24 v8, 144, v2
  v_mul_u32_u24 v9, 2304, v1
  v_add_u32 v8, v8, v9
  v_lshl_add_u32 v8, v3, 4, v8
  s_nop 7
  ds_write_b128 v8, v[112:115] offset:0
  ds_write_b128 v8, v[116:119] offset:64
  s_waitcnt lgkmcnt(0)
  s_barrier
  v_mul_u32_u24 v8, 144, v2
  v_lshl_add_u32 v8, v3, 5, v8

  ds_read_b128 v[16:19], v8 offset:0
  ds_read_b128 v[20:23], v8 offset:16
  ds_read_b128 v[24:27], v8 offset:2304
  ds_read_b128 v[28:31], v8 offset:2320
  ds_read_b128 v[32:35], v8 offset:4608
  ds_read_b128 v[36:39], v8 offset:4624
  ds_read_b128 v[40:43], v8 offset:6912
  ds_read_b128 v[44:47], v8 offset:6928
  v_xor_b32 v10, 16, v0
  v_and_b32 v10, 63, v10
  v_lshlrev_b32 v10, 2, v10
  v_xor_b32 v11, 32, v0
  v_and_b32 v11, 63, v11
  v_lshlrev_b32 v11, 2, v11
  s_waitcnt lgkmcnt(0)

  v_add_f32 v16, v16, v24
  v_add_f32 v32, v32, v40
  v_add_f32 v16, v16, v32
  v_add_f32 v17, v17, v25
  v_add_f32 v33, v33, v41
  v_add_f32 v17, v17, v33
  v_add_f32 v18, v18, v26
  v_add_f32 v34, v34, v42
  v_add_f32 v18, v18, v34
  v_add_f32 v19, v19, v27
  v_add_f32 v35, v35, v43
  v_add_f32 v19, v19, v35
  v_add_f32 v20, v20, v28
  v_add_f32 v36, v36, v44
  v_add_f32 v20, v20, v36
  v_add_f32 v21, v21, v29
  v_add_f32 v37, v37, v45
  v_add_f32 v21, v21, v37
  v_add_f32 v22, v22, v30
  v_add_f32 v38, v38, v46
  v_add_f32 v22, v22, v38
  v_add_f32 v23, v23, v31
  v_add_f32 v39, v39, v47
  v_add_f32 v23, v23, v39
  v_max_f32 v12, v16, v17
  v_max3_f32 v12, v12, v18, v19
  v_max3_f32 v12, v12, v20, v21
  v_max3_f32 v12, v12, v22, v23
  ds_bpermute_b32 v13, v10, v12
  s_waitcnt lgkmcnt(0)
  v_max_f32 v12, v12, v13
  ds_bpermute_b32 v13, v11, v12
  s_waitcnt lgkmcnt(0)
  v_max_f32 v12, v12, v13

  v_sub_f32 v16, v16, v12
  v_exp_f32 v16, v16
  v_sub_f32 v17, v17, v12
  v_exp_f32 v17, v17
  v_sub_f32 v18, v18, v12
  v_exp_f32 v18, v18
  v_sub_f32 v19, v19, v12
  v_exp_f32 v19, v19
  v_sub_f32 v20, v20, v12
  v_exp_f32 v20, v20
  v_sub_f32 v21, v21, v12
  v_exp_f32 v21, v21
  v_sub_f32 v22, v22, v12
  v_exp_f32 v22, v22
  v_sub_f32 v23, v23, v12
  v_exp_f32 v23, v23
  s_nop 0
  v_add_f32 v13, v16, v17
  v_add_f32 v13, v13, v18
  v_add_f32 v13, v13, v19
  v_add_f32 v13, v13, v20
  v_add_f32 v13, v13, v21
  v_add_f32 v13, v13, v22
  v_add_f32 v13, v13, v23
  ds_bpermute_b32 v14, v10, v13
  v_cvt_pk_bf16_f32 v24, v16, v17
  v_cvt_pk_bf16_f32 v25, v18, v19
  v_cvt_pk_bf16_f32 v26, v20, v21
  v_cvt_pk_bf16_f32 v27, v22, v23
  s_waitcnt lgkmcnt(0)
  v_add_f32 v13, v13, v14
  ds_bpermute_b32 v14, v11, v13
  s_waitcnt lgkmcnt(0)
  v_add_f32 v13, v13, v14

  v_bfe_u32 v14, v0, 2, 2
  v_lshl_add_u32 v14, v3, 3, v14
  v_mul_u32_u24 v14, 2064, v14
  v_and_b32 v15, 3, v0
  v_lshl_add_u32 v14, v15, 5, v14
  v_lshl_add_u32 v14, v1, 9, v14
  v_add_u32 v14, 9216, v14

  ds_read_b64_tr_b16 v[32:33], v14 offset:0
  ds_read_b64_tr_b16 v[34:35], v14 offset:8256
  ds_read_b64_tr_b16 v[36:37], v14 offset:8
  ds_read_b64_tr_b16 v[38:39], v14 offset:8264
  ds_read_b64_tr_b16 v[40:41], v14 offset:16
  ds_read_b64_tr_b16 v[42:43], v14 offset:8272
  ds_read_b64_tr_b16 v[44:45], v14 offset:24
  ds_read_b64_tr_b16 v[46:47], v14 offset:8280
  s_waitcnt lgkmcnt(6)
  v_mfma_f32_16x16x32_bf16 v[48:51], v[32:35], v[24:27], 0
  s_waitcnt lgkmcnt(4)
  v_mfma_f32_16x16x32_bf16 v[52:55], v[36:39], v[24:27], 0
  s_waitcnt lgkmcnt(2)
  v_mfma_f32_16x16x32_bf16 v[56:59], v[40:43], v[24:27], 0
  s_waitcnt lgkmcnt(0)
  v_mfma_f32_16x16x32_bf16 v[60:63], v[44:47], v[24:27], 0
  s_nop 7
  s_nop 3
  v_cvt_pk_bf16_f32 v64, v48, v49
  v_cvt_pk_bf16_f32 v65, v50, v51
  v_cvt_pk_bf16_f32 v66, v52, v53
  v_cvt_pk_bf16_f32 v67, v54, v55
  v_cvt_pk_bf16_f32 v68, v56, v57
  v_cvt_pk_bf16_f32 v69, v58, v59
  v_cvt_pk_bf16_f32 v70, v60, v61
  v_cvt_pk_bf16_f32 v71, v62, v63
  s_lshl_b32 s18, s2, 15
  s_add_u32 s18, s18, 1048576
  v_lshlrev_b32 v9, 11, v2
  v_lshl_add_u32 v9, v1, 9, v9
  v_lshl_add_u32 v9, v3, 5, v9
  v_add_u32 v9, s18, v9
  global_store_dwordx4 v9, v[64:67], s[12:13] offset:0
  global_store_dwordx4 v9, v[68:71], s[12:13] offset:16
  s_nop 1
  ds_read_b64_tr_b16 v[32:33], v14 offset:128
  ds_read_b64_tr_b16 v[34:35], v14 offset:8384
  ds_read_b64_tr_b16 v[36:37], v14 offset:136
  ds_read_b64_tr_b16 v[38:39], v14 offset:8392
  ds_read_b64_tr_b16 v[40:41], v14 offset:144
  ds_read_b64_tr_b16 v[42:43], v14 offset:8400
  ds_read_b64_tr_b16 v[44:45], v14 offset:152
  ds_read_b64_tr_b16 v[46:47], v14 offset:8408
  s_waitcnt lgkmcnt(6)
  v_mfma_f32_16x16x32_bf16 v[48:51], v[32:35], v[24:27], 0
  s_waitcnt lgkmcnt(4)
  v_mfma_f32_16x16x32_bf16 v[52:55], v[36:39], v[24:27], 0
  s_waitcnt lgkmcnt(2)
  v_mfma_f32_16x16x32_bf16 v[56:59], v[40:43], v[24:27], 0
  s_waitcnt lgkmcnt(0)
  v_mfma_f32_16x16x32_bf16 v[60:63], v[44:47], v[24:27], 0
  s_nop 7
  s_nop 3
  v_cvt_pk_bf16_f32 v64, v48, v49
  v_cvt_pk_bf16_f32 v65, v50, v51
  v_cvt_pk_bf16_f32 v66, v52, v53
  v_cvt_pk_bf16_f32 v67, v54, v55
  v_cvt_pk_bf16_f32 v68, v56, v57
  v_cvt_pk_bf16_f32 v69, v58, v59
  v_cvt_pk_bf16_f32 v70, v60, v61
  v_cvt_pk_bf16_f32 v71, v62, v63
  global_store_dwordx4 v9, v[64:67], s[12:13] offset:128
  global_store_dwordx4 v9, v[68:71], s[12:13] offset:144
  s_nop 1
  ds_read_b64_tr_b16 v[32:33], v14 offset:256
  ds_read_b64_tr_b16 v[34:35], v14 offset:8512
  ds_read_b64_tr_b16 v[36:37], v14 offset:264
  ds_read_b64_tr_b16 v[38:39], v14 offset:8520
  ds_read_b64_tr_b16 v[40:41], v14 offset:272
  ds_read_b64_tr_b16 v[42:43], v14 offset:8528
  ds_read_b64_tr_b16 v[44:45], v14 offset:280
  ds_read_b64_tr_b16 v[46:47], v14 offset:8536
  s_waitcnt lgkmcnt(6)
  v_mfma_f32_16x16x32_bf16 v[48:51], v[32:35], v[24:27], 0
  s_waitcnt lgkmcnt(4)
  v_mfma_f32_16x16x32_bf16 v[52:55], v[36:39], v[24:27], 0
  s_waitcnt lgkmcnt(2)
  v_mfma_f32_16x16x32_bf16 v[56:59], v[40:43], v[24:27], 0
  s_waitcnt lgkmcnt(0)
  v_mfma_f32_16x16x32_bf16 v[60:63], v[44:47], v[24:27], 0
  s_nop 7
  s_nop 3
  v_cvt_pk_bf16_f32 v64, v48, v49
  v_cvt_pk_bf16_f32 v65, v50, v51
  v_cvt_pk_bf16_f32 v66, v52, v53
  v_cvt_pk_bf16_f32 v67, v54, v55
  v_cvt_pk_bf16_f32 v68, v56, v57
  v_cvt_pk_bf16_f32 v69, v58, v59
  v_cvt_pk_bf16_f32 v70, v60, v61
  v_cvt_pk_bf16_f32 v71, v62, v63
  global_store_dwordx4 v9, v[64:67], s[12:13] offset:256
  global_store_dwordx4 v9, v[68:71], s[12:13] offset:272
  s_nop 1
  ds_read_b64_tr_b16 v[32:33], v14 offset:384
  ds_read_b64_tr_b16 v[34:35], v14 offset:8640
  ds_read_b64_tr_b16 v[36:37], v14 offset:392
  ds_read_b64_tr_b16 v[38:39], v14 offset:8648
  ds_read_b64_tr_b16 v[40:41], v14 offset:400
  ds_read_b64_tr_b16 v[42:43], v14 offset:8656
  ds_read_b64_tr_b16 v[44:45], v14 offset:408
  ds_read_b64_tr_b16 v[46:47], v14 offset:8664
  s_waitcnt lgkmcnt(6)
  v_mfma_f32_16x16x32_bf16 v[48:51], v[32:35], v[24:27], 0
  s_waitcnt lgkmcnt(4)
  v_mfma_f32_16x16x32_bf16 v[52:55], v[36:39], v[24:27], 0
  s_waitcnt lgkmcnt(2)
  v_mfma_f32_16x16x32_bf16 v[56:59], v[40:43], v[24:27], 0
  s_waitcnt lgkmcnt(0)
  v_mfma_f32_16x16x32_bf16 v[60:63], v[44:47], v[24:27], 0
  s_nop 7
  s_nop 3
  v_cvt_pk_bf16_f32 v64, v48, v49
  v_cvt_pk_bf16_f32 v65, v50, v51
  v_cvt_pk_bf16_f32 v66, v52, v53
  v_cvt_pk_bf16_f32 v67, v54, v55
  v_cvt_pk_bf16_f32 v68, v56, v57
  v_cvt_pk_bf16_f32 v69, v58, v59
  v_cvt_pk_bf16_f32 v70, v60, v61
  v_cvt_pk_bf16_f32 v71, v62, v63
  global_store_dwordx4 v9, v[64:67], s[12:13] offset:384
  global_store_dwordx4 v9, v[68:71], s[12:13] offset:400
  s_nop 1
  v_cmp_gt_u32 vcc, 16, v0
  s_and_saveexec_b64 s[24:25], vcc
  s_cbranch_execz k3_end
  s_lshl_b32 s18, s2, 7
  s_add_u32 s18, s18, 327680
  v_lshl_add_u32 v9, v0, 3, s18
  global_store_dwordx2 v9, v[12:13], s[12:13]
k3_end:
  s_endpgm

.globl k4_kernel
.p2align 8
.type k4_kernel,@function
k4_kernel:

  s_cmp_ge_u32 s2, 256
  s_cbranch_scc1 k4_end
  s_load_dwordx2 s[4:5], s[0:1], 32
  s_load_dwordx2 s[12:13], s[0:1], 104
  s_lshr_b32 s14, s2, 4
  s_and_b32 s15, s2, 15
  v_lshrrev_b32 v1, 6, v0
  v_and_b32 v2, 63, v0
  s_lshl_b32 s16, s14, 3
  s_add_u32 s16, s16, 327680
  v_lshlrev_b32 v3, 7, v0
  v_add_u32 v3, s16, v3
  v_lshrrev_b32 v4, 3, v0
  v_lshrrev_b32 v5, 3, v2
  v_lshl_add_u32 v5, v1, 6, v5
  v_lshlrev_b32 v5, 15, v5
  v_and_b32 v6, 7, v0
  v_lshl_add_u32 v5, v6, 4, v5
  s_lshl_b32 s17, s14, 11
  s_lshl_b32 s18, s15, 7
  s_add_u32 s17, s17, s18
  s_add_u32 s17, s17, 1048576
  v_add_u32 v5, s17, v5
  v_lshrrev_b32 v6, 5, v2
  v_lshl_add_u32 v6, v1, 4, v6
  s_lshl_b32 s18, s15, 6
  v_add_u32 v6, s18, v6
  v_lshlrev_b32 v6, 13, v6
  v_and_b32 v7, 31, v0
  v_lshl_add_u32 v6, v7, 4, v6
  s_lshl_b32 s18, s14, 9
  v_add_u32 v6, s18, v6
  s_waitcnt lgkmcnt(0)
  global_load_dwordx2 v[8:9], v3, s[12:13]

  global_load_dwordx4 v[16:19], v5, s[12:13]
  v_add_u32 v5, 0x40000, v5
  global_load_dwordx4 v[20:23], v5, s[12:13]
  v_add_u32 v5, 0x40000, v5
  global_load_dwordx4 v[24:27], v5, s[12:13]
  v_add_u32 v5, 0x40000, v5
  global_load_dwordx4 v[28:31], v5, s[12:13]
  v_add_u32 v5, 0x40000, v5
  global_load_dwordx4 v[32:35], v5, s[12:13]
  v_add_u32 v5, 0x40000, v5
  global_load_dwordx4 v[36:39], v5, s[12:13]
  v_add_u32 v5, 0x40000, v5
  global_load_dwordx4 v[40:43], v5, s[12:13]
  v_add_u32 v5, 0x40000, v5
  global_load_dwordx4 v[44:47], v5, s[12:13]
  v_add_u32 v5, 0x40000, v5
  global_load_dwordx4 v[48:51], v6, s[4:5] nt
  v_add_u32 v6, 0x4000, v6
  global_load_dwordx4 v[52:55], v6, s[4:5] nt
  v_add_u32 v6, 0x4000, v6
  global_load_dwordx4 v[56:59], v6, s[4:5] nt
  v_add_u32 v6, 0x4000, v6
  global_load_dwordx4 v[60:63], v6, s[4:5] nt
  v_add_u32 v6, 0x4000, v6
  global_load_dwordx4 v[64:67], v6, s[4:5] nt
  v_add_u32 v6, 0x4000, v6
  global_load_dwordx4 v[68:71], v6, s[4:5] nt
  v_add_u32 v6, 0x4000, v6
  global_load_dwordx4 v[72:75], v6, s[4:5] nt
  v_add_u32 v6, 0x4000, v6
  global_load_dwordx4 v[76:79], v6, s[4:5] nt
  v_add_u32 v6, 0x4000, v6
  s_waitcnt vmcnt(16)
  v_mov_b32 v10, v8
  DPPRED v_max_f32_dpp, v10,
  v_readlane_b32 s20, v10, 63
  v_lshlrev_b32 v11, 2, v1
  v_mov_b32 v12, s20
  ds_write_b32 v11, v12
  s_waitcnt lgkmcnt(0)
  s_barrier
  v_and_b32 v11, 2, v1
  v_lshlrev_b32 v11, 2, v11
  ds_read_b64 v[12:13], v11
  s_waitcnt lgkmcnt(0)
  v_max_f32 v12, v12, v13
  v_sub_f32 v10, v8, v12
  v_exp_f32 v10, v10
  s_nop 0
  v_mul_f32 v13, v10, v9
  DPPRED v_add_f32_dpp, v13, bound_ctrl:0
  v_readlane_b32 s20, v13, 63
  v_lshlrev_b32 v11, 2, v1
  v_mov_b32 v13, s20
  ds_write_b32 v11, v13 offset:16
  s_waitcnt lgkmcnt(0)
  s_barrier
  v_and_b32 v11, 2, v1
  v_lshlrev_b32 v11, 2, v11
  ds_read_b64 v[12:13], v11 offset:16
  s_waitcnt lgkmcnt(0)
  v_add_f32 v12, v12, v13
  v_rcp_f32 v12, v12
  s_nop 0
  v_mul_f32 v10, v10, v12
  v_lshlrev_b32 v11, 2, v0
  ds_write_b32 v11, v10 offset:64
  s_waitcnt lgkmcnt(0)
  s_barrier
  v_lshrrev_b32 v11, 3, v2
  v_lshl_add_u32 v11, v1, 6, v11
  v_lshlrev_b32 v11, 2, v11

  ds_read_b32 v80, v11 offset:64
  ds_read_b32 v81, v11 offset:96
  ds_read_b32 v82, v11 offset:128
  ds_read_b32 v83, v11 offset:160
  ds_read_b32 v84, v11 offset:192
  ds_read_b32 v85, v11 offset:224
  ds_read_b32 v86, v11 offset:256
  ds_read_b32 v87, v11 offset:288
  v_mov_b32 v88, 0
  v_mov_b32 v89, 0
  v_mov_b32 v90, 0
  v_mov_b32 v91, 0
  v_mov_b32 v92, 0
  v_mov_b32 v93, 0
  v_mov_b32 v94, 0
  v_mov_b32 v95, 0
  s_waitcnt vmcnt(8) lgkmcnt(0)
  v_lshlrev_b32 v12, 16, v16
  v_and_b32 v13, 0xffff0000, v16
  v_fmac_f32 v88, v80, v12
  v_fmac_f32 v89, v80, v13
  v_lshlrev_b32 v12, 16, v17
  v_and_b32 v13, 0xffff0000, v17
  v_fmac_f32 v90, v80, v12
  v_fmac_f32 v91, v80, v13
  v_lshlrev_b32 v12, 16, v18
  v_and_b32 v13, 0xffff0000, v18
  v_fmac_f32 v92, v80, v12
  v_fmac_f32 v93, v80, v13
  v_lshlrev_b32 v12, 16, v19
  v_and_b32 v13, 0xffff0000, v19
  v_fmac_f32 v94, v80, v12
  v_fmac_f32 v95, v80, v13
  v_lshlrev_b32 v12, 16, v20
  v_and_b32 v13, 0xffff0000, v20
  v_fmac_f32 v88, v81, v12
  v_fmac_f32 v89, v81, v13
  v_lshlrev_b32 v12, 16, v21
  v_and_b32 v13, 0xffff0000, v21
  v_fmac_f32 v90, v81, v12
  v_fmac_f32 v91, v81, v13
  v_lshlrev_b32 v12, 16, v22
  v_and_b32 v13, 0xffff0000, v22
  v_fmac_f32 v92, v81, v12
  v_fmac_f32 v93, v81, v13
  v_lshlrev_b32 v12, 16, v23
  v_and_b32 v13, 0xffff0000, v23
  v_fmac_f32 v94, v81, v12
  v_fmac_f32 v95, v81, v13
  v_lshlrev_b32 v12, 16, v24
  v_and_b32 v13, 0xffff0000, v24
  v_fmac_f32 v88, v82, v12
  v_fmac_f32 v89, v82, v13
  v_lshlrev_b32 v12, 16, v25
  v_and_b32 v13, 0xffff0000, v25
  v_fmac_f32 v90, v82, v12
  v_fmac_f32 v91, v82, v13
  v_lshlrev_b32 v12, 16, v26
  v_and_b32 v13, 0xffff0000, v26
  v_fmac_f32 v92, v82, v12
  v_fmac_f32 v93, v82, v13
  v_lshlrev_b32 v12, 16, v27
  v_and_b32 v13, 0xffff0000, v27
  v_fmac_f32 v94, v82, v12
  v_fmac_f32 v95, v82, v13
  v_lshlrev_b32 v12, 16, v28
  v_and_b32 v13, 0xffff0000, v28
  v_fmac_f32 v88, v83, v12
  v_fmac_f32 v89, v83, v13
  v_lshlrev_b32 v12, 16, v29
  v_and_b32 v13, 0xffff0000, v29
  v_fmac_f32 v90, v83, v12
  v_fmac_f32 v91, v83, v13
  v_lshlrev_b32 v12, 16, v30
  v_and_b32 v13, 0xffff0000, v30
  v_fmac_f32 v92, v83, v12
  v_fmac_f32 v93, v83, v13
  v_lshlrev_b32 v12, 16, v31
  v_and_b32 v13, 0xffff0000, v31
  v_fmac_f32 v94, v83, v12
  v_fmac_f32 v95, v83, v13
  v_lshlrev_b32 v12, 16, v32
  v_and_b32 v13, 0xffff0000, v32
  v_fmac_f32 v88, v84, v12
  v_fmac_f32 v89, v84, v13
  v_lshlrev_b32 v12, 16, v33
  v_and_b32 v13, 0xffff0000, v33
  v_fmac_f32 v90, v84, v12
  v_fmac_f32 v91, v84, v13
  v_lshlrev_b32 v12, 16, v34
  v_and_b32 v13, 0xffff0000, v34
  v_fmac_f32 v92, v84, v12
  v_fmac_f32 v93, v84, v13
  v_lshlrev_b32 v12, 16, v35
  v_and_b32 v13, 0xffff0000, v35
  v_fmac_f32 v94, v84, v12
  v_fmac_f32 v95, v84, v13
  v_lshlrev_b32 v12, 16, v36
  v_and_b32 v13, 0xffff0000, v36
  v_fmac_f32 v88, v85, v12
  v_fmac_f32 v89, v85, v13
  v_lshlrev_b32 v12, 16, v37
  v_and_b32 v13, 0xffff0000, v37
  v_fmac_f32 v90, v85, v12
  v_fmac_f32 v91, v85, v13
  v_lshlrev_b32 v12, 16, v38
  v_and_b32 v13, 0xffff0000, v38
  v_fmac_f32 v92, v85, v12
  v_fmac_f32 v93, v85, v13
  v_lshlrev_b32 v12, 16, v39
  v_and_b32 v13, 0xffff0000, v39
  v_fmac_f32 v94, v85, v12
  v_fmac_f32 v95, v85, v13
  v_lshlrev_b32 v12, 16, v40
  v_and_b32 v13, 0xffff0000, v40
  v_fmac_f32 v88, v86, v12
  v_fmac_f32 v89, v86, v13
  v_lshlrev_b32 v12, 16, v41
  v_and_b32 v13, 0xffff0000, v41
  v_fmac_f32 v90, v86, v12
  v_fmac_f32 v91, v86, v13
  v_lshlrev_b32 v12, 16, v42
  v_and_b32 v13, 0xffff0000, v42
  v_fmac_f32 v92, v86, v12
  v_fmac_f32 v93, v86, v13
  v_lshlrev_b32 v12, 16, v43
  v_and_b32 v13, 0xffff0000, v43
  v_fmac_f32 v94, v86, v12
  v_fmac_f32 v95, v86, v13
  v_lshlrev_b32 v12, 16, v44
  v_and_b32 v13, 0xffff0000, v44
  v_fmac_f32 v88, v87, v12
  v_fmac_f32 v89, v87, v13
  v_lshlrev_b32 v12, 16, v45
  v_and_b32 v13, 0xffff0000, v45
  v_fmac_f32 v90, v87, v12
  v_fmac_f32 v91, v87, v13
  v_lshlrev_b32 v12, 16, v46
  v_and_b32 v13, 0xffff0000, v46
  v_fmac_f32 v92, v87, v12
  v_fmac_f32 v93, v87, v13
  v_lshlrev_b32 v12, 16, v47
  v_and_b32 v13, 0xffff0000, v47
  v_fmac_f32 v94, v87, v12
  v_fmac_f32 v95, v87, v13
  v_lshrrev_b32 v11, 3, v0
  v_lshlrev_b32 v11, 8, v11
  v_and_b32 v12, 7, v0
  v_lshl_add_u32 v11, v12, 5, v11
  ds_write_b128 v11, v[88:91] offset:2048
  ds_write_b128 v11, v[92:95] offset:2064
  s_waitcnt lgkmcnt(0)
  s_barrier
  v_lshrrev_b32 v11, 6, v0
  v_lshlrev_b32 v11, 12, v11
  v_lshl_add_u32 v11, v2, 2, v11

  ds_read_b32 v16, v11 offset:2048
  ds_read_b32 v17, v11 offset:2304
  ds_read_b32 v18, v11 offset:2560
  ds_read_b32 v19, v11 offset:2816
  ds_read_b32 v20, v11 offset:3072
  ds_read_b32 v21, v11 offset:3328
  ds_read_b32 v22, v11 offset:3584
  ds_read_b32 v23, v11 offset:3840
  ds_read_b32 v24, v11 offset:4096
  ds_read_b32 v25, v11 offset:4352
  ds_read_b32 v26, v11 offset:4608
  ds_read_b32 v27, v11 offset:4864
  ds_read_b32 v28, v11 offset:5120
  ds_read_b32 v29, v11 offset:5376
  ds_read_b32 v30, v11 offset:5632
  ds_read_b32 v31, v11 offset:5888
  s_waitcnt lgkmcnt(0)
  v_add_f32 v16, v16, v17
  v_add_f32 v16, v16, v18
  v_add_f32 v16, v16, v19
  v_add_f32 v16, v16, v20
  v_add_f32 v16, v16, v21
  v_add_f32 v16, v16, v22
  v_add_f32 v16, v16, v23
  v_add_f32 v16, v16, v24
  v_add_f32 v16, v16, v25
  v_add_f32 v16, v16, v26
  v_add_f32 v16, v16, v27
  v_add_f32 v16, v16, v28
  v_add_f32 v16, v16, v29
  v_add_f32 v16, v16, v30
  v_add_f32 v16, v16, v31
  v_lshlrev_b32 v11, 2, v0
  v_cmp_gt_u32 vcc, 128, v0
  s_and_saveexec_b64 s[24:25], vcc
  ds_write_b32 v11, v16 offset:1280
  s_mov_b64 exec, s[24:25]
  s_waitcnt lgkmcnt(0)
  s_barrier
  v_lshrrev_b32 v11, 5, v2
  v_lshl_add_u32 v11, v1, 4, v11
  v_lshlrev_b32 v11, 2, v11

  ds_read_b32 v80, v11 offset:1280
  ds_read_b32 v96, v11 offset:1536
  ds_read_b32 v81, v11 offset:1288
  ds_read_b32 v97, v11 offset:1544
  ds_read_b32 v82, v11 offset:1296
  ds_read_b32 v98, v11 offset:1552
  ds_read_b32 v83, v11 offset:1304
  ds_read_b32 v99, v11 offset:1560
  ds_read_b32 v84, v11 offset:1312
  ds_read_b32 v100, v11 offset:1568
  ds_read_b32 v85, v11 offset:1320
  ds_read_b32 v101, v11 offset:1576
  ds_read_b32 v86, v11 offset:1328
  ds_read_b32 v102, v11 offset:1584
  ds_read_b32 v87, v11 offset:1336
  ds_read_b32 v103, v11 offset:1592
  v_mov_b32 v112, 0
  v_mov_b32 v113, 0
  v_mov_b32 v114, 0
  v_mov_b32 v115, 0
  v_mov_b32 v116, 0
  v_mov_b32 v117, 0
  v_mov_b32 v118, 0
  v_mov_b32 v119, 0
  v_mov_b32 v120, 0
  v_mov_b32 v121, 0
  v_mov_b32 v122, 0
  v_mov_b32 v123, 0
  v_mov_b32 v124, 0
  v_mov_b32 v125, 0
  v_mov_b32 v126, 0
  v_mov_b32 v127, 0
  s_waitcnt vmcnt(0) lgkmcnt(0)
  v_lshlrev_b32 v12, 16, v48
  v_and_b32 v13, 0xffff0000, v48
  v_fmac_f32 v112, v80, v12
  v_fmac_f32 v113, v80, v13
  v_fmac_f32 v120, v96, v12
  v_fmac_f32 v121, v96, v13
  v_lshlrev_b32 v12, 16, v49
  v_and_b32 v13, 0xffff0000, v49
  v_fmac_f32 v114, v80, v12
  v_fmac_f32 v115, v80, v13
  v_fmac_f32 v122, v96, v12
  v_fmac_f32 v123, v96, v13
  v_lshlrev_b32 v12, 16, v50
  v_and_b32 v13, 0xffff0000, v50
  v_fmac_f32 v116, v80, v12
  v_fmac_f32 v117, v80, v13
  v_fmac_f32 v124, v96, v12
  v_fmac_f32 v125, v96, v13
  v_lshlrev_b32 v12, 16, v51
  v_and_b32 v13, 0xffff0000, v51
  v_fmac_f32 v118, v80, v12
  v_fmac_f32 v119, v80, v13
  v_fmac_f32 v126, v96, v12
  v_fmac_f32 v127, v96, v13
  v_lshlrev_b32 v12, 16, v52
  v_and_b32 v13, 0xffff0000, v52
  v_fmac_f32 v112, v81, v12
  v_fmac_f32 v113, v81, v13
  v_fmac_f32 v120, v97, v12
  v_fmac_f32 v121, v97, v13
  v_lshlrev_b32 v12, 16, v53
  v_and_b32 v13, 0xffff0000, v53
  v_fmac_f32 v114, v81, v12
  v_fmac_f32 v115, v81, v13
  v_fmac_f32 v122, v97, v12
  v_fmac_f32 v123, v97, v13
  v_lshlrev_b32 v12, 16, v54
  v_and_b32 v13, 0xffff0000, v54
  v_fmac_f32 v116, v81, v12
  v_fmac_f32 v117, v81, v13
  v_fmac_f32 v124, v97, v12
  v_fmac_f32 v125, v97, v13
  v_lshlrev_b32 v12, 16, v55
  v_and_b32 v13, 0xffff0000, v55
  v_fmac_f32 v118, v81, v12
  v_fmac_f32 v119, v81, v13
  v_fmac_f32 v126, v97, v12
  v_fmac_f32 v127, v97, v13
  v_lshlrev_b32 v12, 16, v56
  v_and_b32 v13, 0xffff0000, v56
  v_fmac_f32 v112, v82, v12
  v_fmac_f32 v113, v82, v13
  v_fmac_f32 v120, v98, v12
  v_fmac_f32 v121, v98, v13
  v_lshlrev_b32 v12, 16, v57
  v_and_b32 v13, 0xffff0000, v57
  v_fmac_f32 v114, v82, v12
  v_fmac_f32 v115, v82, v13
  v_fmac_f32 v122, v98, v12
  v_fmac_f32 v123, v98, v13
  v_lshlrev_b32 v12, 16, v58
  v_and_b32 v13, 0xffff0000, v58
  v_fmac_f32 v116, v82, v12
  v_fmac_f32 v117, v82, v13
  v_fmac_f32 v124, v98, v12
  v_fmac_f32 v125, v98, v13
  v_lshlrev_b32 v12, 16, v59
  v_and_b32 v13, 0xffff0000, v59
  v_fmac_f32 v118, v82, v12
  v_fmac_f32 v119, v82, v13
  v_fmac_f32 v126, v98, v12
  v_fmac_f32 v127, v98, v13
  v_lshlrev_b32 v12, 16, v60
  v_and_b32 v13, 0xffff0000, v60
  v_fmac_f32 v112, v83, v12
  v_fmac_f32 v113, v83, v13
  v_fmac_f32 v120, v99, v12
  v_fmac_f32 v121, v99, v13
  v_lshlrev_b32 v12, 16, v61
  v_and_b32 v13, 0xffff0000, v61
  v_fmac_f32 v114, v83, v12
  v_fmac_f32 v115, v83, v13
  v_fmac_f32 v122, v99, v12
  v_fmac_f32 v123, v99, v13
  v_lshlrev_b32 v12, 16, v62
  v_and_b32 v13, 0xffff0000, v62
  v_fmac_f32 v116, v83, v12
  v_fmac_f32 v117, v83, v13
  v_fmac_f32 v124, v99, v12
  v_fmac_f32 v125, v99, v13
  v_lshlrev_b32 v12, 16, v63
  v_and_b32 v13, 0xffff0000, v63
  v_fmac_f32 v118, v83, v12
  v_fmac_f32 v119, v83, v13
  v_fmac_f32 v126, v99, v12
  v_fmac_f32 v127, v99, v13
  v_lshlrev_b32 v12, 16, v64
  v_and_b32 v13, 0xffff0000, v64
  v_fmac_f32 v112, v84, v12
  v_fmac_f32 v113, v84, v13
  v_fmac_f32 v120, v100, v12
  v_fmac_f32 v121, v100, v13
  v_lshlrev_b32 v12, 16, v65
  v_and_b32 v13, 0xffff0000, v65
  v_fmac_f32 v114, v84, v12
  v_fmac_f32 v115, v84, v13
  v_fmac_f32 v122, v100, v12
  v_fmac_f32 v123, v100, v13
  v_lshlrev_b32 v12, 16, v66
  v_and_b32 v13, 0xffff0000, v66
  v_fmac_f32 v116, v84, v12
  v_fmac_f32 v117, v84, v13
  v_fmac_f32 v124, v100, v12
  v_fmac_f32 v125, v100, v13
  v_lshlrev_b32 v12, 16, v67
  v_and_b32 v13, 0xffff0000, v67
  v_fmac_f32 v118, v84, v12
  v_fmac_f32 v119, v84, v13
  v_fmac_f32 v126, v100, v12
  v_fmac_f32 v127, v100, v13
  v_lshlrev_b32 v12, 16, v68
  v_and_b32 v13, 0xffff0000, v68
  v_fmac_f32 v112, v85, v12
  v_fmac_f32 v113, v85, v13
  v_fmac_f32 v120, v101, v12
  v_fmac_f32 v121, v101, v13
  v_lshlrev_b32 v12, 16, v69
  v_and_b32 v13, 0xffff0000, v69
  v_fmac_f32 v114, v85, v12
  v_fmac_f32 v115, v85, v13
  v_fmac_f32 v122, v101, v12
  v_fmac_f32 v123, v101, v13
  v_lshlrev_b32 v12, 16, v70
  v_and_b32 v13, 0xffff0000, v70
  v_fmac_f32 v116, v85, v12
  v_fmac_f32 v117, v85, v13
  v_fmac_f32 v124, v101, v12
  v_fmac_f32 v125, v101, v13
  v_lshlrev_b32 v12, 16, v71
  v_and_b32 v13, 0xffff0000, v71
  v_fmac_f32 v118, v85, v12
  v_fmac_f32 v119, v85, v13
  v_fmac_f32 v126, v101, v12
  v_fmac_f32 v127, v101, v13
  v_lshlrev_b32 v12, 16, v72
  v_and_b32 v13, 0xffff0000, v72
  v_fmac_f32 v112, v86, v12
  v_fmac_f32 v113, v86, v13
  v_fmac_f32 v120, v102, v12
  v_fmac_f32 v121, v102, v13
  v_lshlrev_b32 v12, 16, v73
  v_and_b32 v13, 0xffff0000, v73
  v_fmac_f32 v114, v86, v12
  v_fmac_f32 v115, v86, v13
  v_fmac_f32 v122, v102, v12
  v_fmac_f32 v123, v102, v13
  v_lshlrev_b32 v12, 16, v74
  v_and_b32 v13, 0xffff0000, v74
  v_fmac_f32 v116, v86, v12
  v_fmac_f32 v117, v86, v13
  v_fmac_f32 v124, v102, v12
  v_fmac_f32 v125, v102, v13
  v_lshlrev_b32 v12, 16, v75
  v_and_b32 v13, 0xffff0000, v75
  v_fmac_f32 v118, v86, v12
  v_fmac_f32 v119, v86, v13
  v_fmac_f32 v126, v102, v12
  v_fmac_f32 v127, v102, v13
  v_lshlrev_b32 v12, 16, v76
  v_and_b32 v13, 0xffff0000, v76
  v_fmac_f32 v112, v87, v12
  v_fmac_f32 v113, v87, v13
  v_fmac_f32 v120, v103, v12
  v_fmac_f32 v121, v103, v13
  v_lshlrev_b32 v12, 16, v77
  v_and_b32 v13, 0xffff0000, v77
  v_fmac_f32 v114, v87, v12
  v_fmac_f32 v115, v87, v13
  v_fmac_f32 v122, v103, v12
  v_fmac_f32 v123, v103, v13
  v_lshlrev_b32 v12, 16, v78
  v_and_b32 v13, 0xffff0000, v78
  v_fmac_f32 v116, v87, v12
  v_fmac_f32 v117, v87, v13
  v_fmac_f32 v124, v103, v12
  v_fmac_f32 v125, v103, v13
  v_lshlrev_b32 v12, 16, v79
  v_and_b32 v13, 0xffff0000, v79
  v_fmac_f32 v118, v87, v12
  v_fmac_f32 v119, v87, v13
  v_fmac_f32 v126, v103, v12
  v_fmac_f32 v127, v103, v13
  v_lshrrev_b32 v11, 5, v0
  v_lshlrev_b32 v11, 11, v11
  v_and_b32 v12, 31, v0
  v_lshl_add_u32 v11, v12, 5, v11
  ds_write_b128 v11, v[112:115] offset:2048
  ds_write_b128 v11, v[116:119] offset:2064
  ds_write_b128 v11, v[120:123] offset:3072
  ds_write_b128 v11, v[124:127] offset:3088
  s_waitcnt lgkmcnt(0)
  s_barrier
  v_lshlrev_b32 v11, 3, v0

  ds_read_b64 v[16:17], v11 offset:2048
  ds_read_b64 v[18:19], v11 offset:4096
  ds_read_b64 v[20:21], v11 offset:6144
  ds_read_b64 v[22:23], v11 offset:8192
  ds_read_b64 v[24:25], v11 offset:10240
  ds_read_b64 v[26:27], v11 offset:12288
  ds_read_b64 v[28:29], v11 offset:14336
  ds_read_b64 v[30:31], v11 offset:16384
  s_waitcnt lgkmcnt(0)
  v_add_f32 v16, v16, v18
  v_add_f32 v17, v17, v19
  v_add_f32 v16, v16, v20
  v_add_f32 v17, v17, v21
  v_add_f32 v16, v16, v22
  v_add_f32 v17, v17, v23
  v_add_f32 v16, v16, v24
  v_add_f32 v17, v17, v25
  v_add_f32 v16, v16, v26
  v_add_f32 v17, v17, v27
  v_add_f32 v16, v16, v28
  v_add_f32 v17, v17, v29
  v_add_f32 v16, v16, v30
  v_add_f32 v17, v17, v31
  v_lshrrev_b32 v11, 7, v0
  v_lshlrev_b32 v11, 14, v11
  v_and_b32 v12, 127, v0
  v_lshl_add_u32 v11, v12, 3, v11
  s_lshl_b32 s18, s15, 15
  s_lshl_b32 s19, s14, 10
  s_add_u32 s18, s18, s19
  s_add_u32 s18, s18, 524288
  v_add_u32 v11, s18, v11
  global_store_dwordx2 v11, v[16:17], s[12:13]
k4_end:
  s_endpgm

.globl k5_kernel
.p2align 8
.type k5_kernel,@function
k5_kernel:

  s_cmp_ge_u32 s2, 184
  s_cbranch_scc1 k5_end
  s_load_dwordx2 s[4:5], s[0:1], 40
  s_load_dwordx2 s[6:7], s[0:1], 72
  s_load_dwordx2 s[12:13], s[0:1], 104
  s_load_dwordx2 s[8:9], s[0:1], 0
  s_load_dwordx2 s[10:11], s[0:1], 80
  s_load_dwordx2 s[26:27], s[0:1], 88
  s_load_dwordx2 s[28:29], s[0:1], 96
  v_lshrrev_b32 v1, 6, v0
  v_and_b32 v2, 63, v0
  s_sub_u32 s20, s2, 128
  s_waitcnt lgkmcnt(0)
  s_cmp_lt_u32 s2, 128
  s_cselect_b32 s16, s4, s6
  s_cselect_b32 s17, s5, s7
  s_cselect_b32 s18, s2, s20
  s_mul_i32 s18, s18, 28672
  v_mul_u32_u24 v3, 7168, v1
  v_lshl_add_u32 v3, v2, 4, v3
  v_add_u32 v3, s18, v3
  v_cmp_gt_u32 vcc, 56, v2
  s_and_saveexec_b64 s[24:25], vcc

  global_load_dwordx4 v[16:19], v3, s[16:17] offset:0 nt
  global_load_dwordx4 v[20:23], v3, s[16:17] offset:896 nt
  global_load_dwordx4 v[24:27], v3, s[16:17] offset:1792 nt
  global_load_dwordx4 v[28:31], v3, s[16:17] offset:2688 nt
  v_add_u32 v3, 3584, v3
  global_load_dwordx4 v[32:35], v3, s[16:17] offset:0 nt
  global_load_dwordx4 v[36:39], v3, s[16:17] offset:896 nt
  global_load_dwordx4 v[40:43], v3, s[16:17] offset:1792 nt
  global_load_dwordx4 v[44:47], v3, s[16:17] offset:2688 nt
  s_mov_b64 exec, s[24:25]
  s_cmp_lt_u32 s2, 128
  s_cbranch_scc0 k5_mlpvec
  v_lshrrev_b32 v4, 5, v2
  v_lshlrev_b32 v4, 14, v4
  v_and_b32 v5, 31, v2
  v_lshl_add_u32 v4, v5, 2, v4
  v_lshl_add_u32 v4, v1, 17, v4
  s_lshl_b32 s19, s2, 7
  s_add_u32 s19, s19, 524288
  v_add_u32 v4, s19, v4
  global_load_dword v8, v4, s[12:13]
  v_add_u32 v4, 0x8000, v4
  global_load_dword v9, v4, s[12:13]
  v_add_u32 v4, 0x8000, v4
  global_load_dword v10, v4, s[12:13]
  v_add_u32 v4, 0x8000, v4
  global_load_dword v11, v4, s[12:13]
  s_waitcnt vmcnt(0)
  v_add_f32 v8, v8, v9
  v_add_f32 v10, v10, v11
  v_add_f32 v8, v8, v10
  v_lshlrev_b32 v5, 2, v0
  ds_write_b32 v5, v8
  s_waitcnt lgkmcnt(0)
  s_barrier
  v_lshlrev_b32 v5, 2, v2
  ds_read_b32 v8, v5
  ds_read_b32 v9, v5 offset:256
  ds_read_b32 v10, v5 offset:512
  ds_read_b32 v11, v5 offset:768
  s_waitcnt lgkmcnt(0)
  v_add_f32 v8, v8, v9
  v_add_f32 v10, v10, v11
  v_add_f32 v8, v8, v10
  v_cvt_pk_bf16_f32 v8, v8, v8
  v_lshlrev_b32 v8, 16, v8
  s_branch k5_vec
k5_mlpvec:
  v_lshrrev_b32 v4, 5, v2
  v_mul_u32_u24 v4, 7168, v4
  v_and_b32 v5, 31, v2
  v_lshl_add_u32 v4, v5, 2, v4
  s_lshl_b32 s19, s20, 7
  s_add_u32 s19, s19, 65536
  v_add_u32 v4, s19, v4
  global_load_dword v8, v4, s[12:13]
  s_waitcnt vmcnt(0)
k5_vec:

  v_mov_b32 v112, 0
  v_mov_b32 v113, 0
  v_mov_b32 v114, 0
  v_mov_b32 v115, 0
  v_mov_b32 v116, 0
  v_mov_b32 v117, 0
  v_mov_b32 v118, 0
  v_mov_b32 v119, 0
  v_mov_b32 v120, 0
  v_mov_b32 v121, 0
  v_mov_b32 v122, 0
  v_mov_b32 v123, 0
  v_mov_b32 v124, 0
  v_mov_b32 v125, 0
  v_mov_b32 v126, 0
  v_mov_b32 v127, 0
  s_waitcnt vmcnt(0)
  v_readfirstlane_b32 s21, v1
  s_lshl_b32 s21, s21, 3
  s_add_u32 s22, s21, 0
  s_add_u32 s23, s21, 32
  v_readlane_b32 s30, v8, s22
  v_readlane_b32 s31, v8, s23
  s_nop 1
  v_lshlrev_b32 v12, 16, v16
  v_and_b32 v13, 0xffff0000, v16
  v_fmac_f32 v112, s30, v12
  v_fmac_f32 v113, s30, v13
  v_fmac_f32 v120, s31, v12
  v_fmac_f32 v121, s31, v13
  v_lshlrev_b32 v12, 16, v17
  v_and_b32 v13, 0xffff0000, v17
  v_fmac_f32 v114, s30, v12
  v_fmac_f32 v115, s30, v13
  v_fmac_f32 v122, s31, v12
  v_fmac_f32 v123, s31, v13
  v_lshlrev_b32 v12, 16, v18
  v_and_b32 v13, 0xffff0000, v18
  v_fmac_f32 v116, s30, v12
  v_fmac_f32 v117, s30, v13
  v_fmac_f32 v124, s31, v12
  v_fmac_f32 v125, s31, v13
  v_lshlrev_b32 v12, 16, v19
  v_and_b32 v13, 0xffff0000, v19
  v_fmac_f32 v118, s30, v12
  v_fmac_f32 v119, s30, v13
  v_fmac_f32 v126, s31, v12
  v_fmac_f32 v127, s31, v13
  s_add_u32 s22, s21, 1
  s_add_u32 s23, s21, 33
  v_readlane_b32 s30, v8, s22
  v_readlane_b32 s31, v8, s23
  s_nop 1
  v_lshlrev_b32 v12, 16, v20
  v_and_b32 v13, 0xffff0000, v20
  v_fmac_f32 v112, s30, v12
  v_fmac_f32 v113, s30, v13
  v_fmac_f32 v120, s31, v12
  v_fmac_f32 v121, s31, v13
  v_lshlrev_b32 v12, 16, v21
  v_and_b32 v13, 0xffff0000, v21
  v_fmac_f32 v114, s30, v12
  v_fmac_f32 v115, s30, v13
  v_fmac_f32 v122, s31, v12
  v_fmac_f32 v123, s31, v13
  v_lshlrev_b32 v12, 16, v22
  v_and_b32 v13, 0xffff0000, v22
  v_fmac_f32 v116, s30, v12
  v_fmac_f32 v117, s30, v13
  v_fmac_f32 v124, s31, v12
  v_fmac_f32 v125, s31, v13
  v_lshlrev_b32 v12, 16, v23
  v_and_b32 v13, 0xffff0000, v23
  v_fmac_f32 v118, s30, v12
  v_fmac_f32 v119, s30, v13
  v_fmac_f32 v126, s31, v12
  v_fmac_f32 v127, s31, v13
  s_add_u32 s22, s21, 2
  s_add_u32 s23, s21, 34
  v_readlane_b32 s30, v8, s22
  v_readlane_b32 s31, v8, s23
  s_nop 1
  v_lshlrev_b32 v12, 16, v24
  v_and_b32 v13, 0xffff0000, v24
  v_fmac_f32 v112, s30, v12
  v_fmac_f32 v113, s30, v13
  v_fmac_f32 v120, s31, v12
  v_fmac_f32 v121, s31, v13
  v_lshlrev_b32 v12, 16, v25
  v_and_b32 v13, 0xffff0000, v25
  v_fmac_f32 v114, s30, v12
  v_fmac_f32 v115, s30, v13
  v_fmac_f32 v122, s31, v12
  v_fmac_f32 v123, s31, v13
  v_lshlrev_b32 v12, 16, v26
  v_and_b32 v13, 0xffff0000, v26
  v_fmac_f32 v116, s30, v12
  v_fmac_f32 v117, s30, v13
  v_fmac_f32 v124, s31, v12
  v_fmac_f32 v125, s31, v13
  v_lshlrev_b32 v12, 16, v27
  v_and_b32 v13, 0xffff0000, v27
  v_fmac_f32 v118, s30, v12
  v_fmac_f32 v119, s30, v13
  v_fmac_f32 v126, s31, v12
  v_fmac_f32 v127, s31, v13
  s_add_u32 s22, s21, 3
  s_add_u32 s23, s21, 35
  v_readlane_b32 s30, v8, s22
  v_readlane_b32 s31, v8, s23
  s_nop 1
  v_lshlrev_b32 v12, 16, v28
  v_and_b32 v13, 0xffff0000, v28
  v_fmac_f32 v112, s30, v12
  v_fmac_f32 v113, s30, v13
  v_fmac_f32 v120, s31, v12
  v_fmac_f32 v121, s31, v13
  v_lshlrev_b32 v12, 16, v29
  v_and_b32 v13, 0xffff0000, v29
  v_fmac_f32 v114, s30, v12
  v_fmac_f32 v115, s30, v13
  v_fmac_f32 v122, s31, v12
  v_fmac_f32 v123, s31, v13
  v_lshlrev_b32 v12, 16, v30
  v_and_b32 v13, 0xffff0000, v30
  v_fmac_f32 v116, s30, v12
  v_fmac_f32 v117, s30, v13
  v_fmac_f32 v124, s31, v12
  v_fmac_f32 v125, s31, v13
  v_lshlrev_b32 v12, 16, v31
  v_and_b32 v13, 0xffff0000, v31
  v_fmac_f32 v118, s30, v12
  v_fmac_f32 v119, s30, v13
  v_fmac_f32 v126, s31, v12
  v_fmac_f32 v127, s31, v13
  s_add_u32 s22, s21, 4
  s_add_u32 s23, s21, 36
  v_readlane_b32 s30, v8, s22
  v_readlane_b32 s31, v8, s23
  s_nop 1
  v_lshlrev_b32 v12, 16, v32
  v_and_b32 v13, 0xffff0000, v32
  v_fmac_f32 v112, s30, v12
  v_fmac_f32 v113, s30, v13
  v_fmac_f32 v120, s31, v12
  v_fmac_f32 v121, s31, v13
  v_lshlrev_b32 v12, 16, v33
  v_and_b32 v13, 0xffff0000, v33
  v_fmac_f32 v114, s30, v12
  v_fmac_f32 v115, s30, v13
  v_fmac_f32 v122, s31, v12
  v_fmac_f32 v123, s31, v13
  v_lshlrev_b32 v12, 16, v34
  v_and_b32 v13, 0xffff0000, v34
  v_fmac_f32 v116, s30, v12
  v_fmac_f32 v117, s30, v13
  v_fmac_f32 v124, s31, v12
  v_fmac_f32 v125, s31, v13
  v_lshlrev_b32 v12, 16, v35
  v_and_b32 v13, 0xffff0000, v35
  v_fmac_f32 v118, s30, v12
  v_fmac_f32 v119, s30, v13
  v_fmac_f32 v126, s31, v12
  v_fmac_f32 v127, s31, v13
  s_add_u32 s22, s21, 5
  s_add_u32 s23, s21, 37
  v_readlane_b32 s30, v8, s22
  v_readlane_b32 s31, v8, s23
  s_nop 1
  v_lshlrev_b32 v12, 16, v36
  v_and_b32 v13, 0xffff0000, v36
  v_fmac_f32 v112, s30, v12
  v_fmac_f32 v113, s30, v13
  v_fmac_f32 v120, s31, v12
  v_fmac_f32 v121, s31, v13
  v_lshlrev_b32 v12, 16, v37
  v_and_b32 v13, 0xffff0000, v37
  v_fmac_f32 v114, s30, v12
  v_fmac_f32 v115, s30, v13
  v_fmac_f32 v122, s31, v12
  v_fmac_f32 v123, s31, v13
  v_lshlrev_b32 v12, 16, v38
  v_and_b32 v13, 0xffff0000, v38
  v_fmac_f32 v116, s30, v12
  v_fmac_f32 v117, s30, v13
  v_fmac_f32 v124, s31, v12
  v_fmac_f32 v125, s31, v13
  v_lshlrev_b32 v12, 16, v39
  v_and_b32 v13, 0xffff0000, v39
  v_fmac_f32 v118, s30, v12
  v_fmac_f32 v119, s30, v13
  v_fmac_f32 v126, s31, v12
  v_fmac_f32 v127, s31, v13
  s_add_u32 s22, s21, 6
  s_add_u32 s23, s21, 38
  v_readlane_b32 s30, v8, s22
  v_readlane_b32 s31, v8, s23
  s_nop 1
  v_lshlrev_b32 v12, 16, v40
  v_and_b32 v13, 0xffff0000, v40
  v_fmac_f32 v112, s30, v12
  v_fmac_f32 v113, s30, v13
  v_fmac_f32 v120, s31, v12
  v_fmac_f32 v121, s31, v13
  v_lshlrev_b32 v12, 16, v41
  v_and_b32 v13, 0xffff0000, v41
  v_fmac_f32 v114, s30, v12
  v_fmac_f32 v115, s30, v13
  v_fmac_f32 v122, s31, v12
  v_fmac_f32 v123, s31, v13
  v_lshlrev_b32 v12, 16, v42
  v_and_b32 v13, 0xffff0000, v42
  v_fmac_f32 v116, s30, v12
  v_fmac_f32 v117, s30, v13
  v_fmac_f32 v124, s31, v12
  v_fmac_f32 v125, s31, v13
  v_lshlrev_b32 v12, 16, v43
  v_and_b32 v13, 0xffff0000, v43
  v_fmac_f32 v118, s30, v12
  v_fmac_f32 v119, s30, v13
  v_fmac_f32 v126, s31, v12
  v_fmac_f32 v127, s31, v13
  s_add_u32 s22, s21, 7
  s_add_u32 s23, s21, 39
  v_readlane_b32 s30, v8, s22
  v_readlane_b32 s31, v8, s23
  s_nop 1
  v_lshlrev_b32 v12, 16, v44
  v_and_b32 v13, 0xffff0000, v44
  v_fmac_f32 v112, s30, v12
  v_fmac_f32 v113, s30, v13
  v_fmac_f32 v120, s31, v12
  v_fmac_f32 v121, s31, v13
  v_lshlrev_b32 v12, 16, v45
  v_and_b32 v13, 0xffff0000, v45
  v_fmac_f32 v114, s30, v12
  v_fmac_f32 v115, s30, v13
  v_fmac_f32 v122, s31, v12
  v_fmac_f32 v123, s31, v13
  v_lshlrev_b32 v12, 16, v46
  v_and_b32 v13, 0xffff0000, v46
  v_fmac_f32 v116, s30, v12
  v_fmac_f32 v117, s30, v13
  v_fmac_f32 v124, s31, v12
  v_fmac_f32 v125, s31, v13
  v_lshlrev_b32 v12, 16, v47
  v_and_b32 v13, 0xffff0000, v47
  v_fmac_f32 v118, s30, v12
  v_fmac_f32 v119, s30, v13
  v_fmac_f32 v126, s31, v12
  v_fmac_f32 v127, s31, v13
  s_barrier
  v_mul_u32_u24 v4, 3584, v1
  v_lshl_add_u32 v4, v2, 5, v4
  s_and_saveexec_b64 s[24:25], vcc
  ds_write_b128 v4, v[112:115]
  ds_write_b128 v4, v[116:119] offset:16
  ds_write_b128 v4, v[120:123] offset:1792
  ds_write_b128 v4, v[124:127] offset:1808
  s_mov_b64 exec, s[24:25]
  s_waitcnt lgkmcnt(0)
  s_barrier
  v_lshlrev_b32 v4, 4, v0
  v_cmp_gt_u32 vcc, 224, v0
  s_and_saveexec_b64 s[24:25], vcc
  s_cbranch_execz k5_atom_done
  ds_read_b128 v[16:19], v4
  ds_read_b128 v[20:23], v4 offset:3584
  ds_read_b128 v[24:27], v4 offset:7168
  ds_read_b128 v[28:31], v4 offset:10752
  s_and_b32 s19, s2, 7
  s_mul_i32 s19, s19, 3584
  s_add_u32 s19, s19, 131072
  v_add_u32 v5, s19, v4
  s_waitcnt lgkmcnt(0)

  v_add_f32 v16, v16, v20
  v_add_f32 v24, v24, v28
  v_add_f32 v16, v16, v24
  v_add_f32 v17, v17, v21
  v_add_f32 v25, v25, v29
  v_add_f32 v17, v17, v25
  v_add_f32 v18, v18, v22
  v_add_f32 v26, v26, v30
  v_add_f32 v18, v18, v26
  v_add_f32 v19, v19, v23
  v_add_f32 v27, v27, v31
  v_add_f32 v19, v19, v27
  global_atomic_add_f32 v5, v16, s[12:13] offset:0
  global_atomic_add_f32 v5, v17, s[12:13] offset:4
  global_atomic_add_f32 v5, v18, s[12:13] offset:8
  global_atomic_add_f32 v5, v19, s[12:13] offset:12
  s_waitcnt vmcnt(0)
k5_atom_done:
  s_mov_b64 exec, s[24:25]
  s_barrier
  v_cmp_eq_u32 vcc, 0, v0
  s_and_saveexec_b64 s[24:25], vcc
  v_mov_b32 v6, 0
  v_mov_b32 v7, 1
  s_cbranch_execz k5_cnt_done
  global_atomic_add v7, v6, v7, s[28:29] sc0
  s_waitcnt vmcnt(0)
  v_mov_b32 v6, 0
  ds_write_b32 v6, v7 offset:15360
  s_waitcnt lgkmcnt(0)
k5_cnt_done:
  s_mov_b64 exec, s[24:25]
  s_barrier
  v_mov_b32 v6, 0
  ds_read_b32 v7, v6 offset:15360
  s_waitcnt lgkmcnt(0)
  s_nop 0
  v_readfirstlane_b32 s19, v7
  s_cmp_eq_u32 s19, 183
  s_cbranch_scc0 k5_end
  v_cmp_gt_u32 vcc, 224, v0
  s_and_saveexec_b64 s[24:25], vcc
  s_cbranch_execz k5_end
  v_lshlrev_b32 v4, 4, v0
  v_add_u32 v5, 131072, v4

  global_load_dwordx4 v[16:19], v5, s[12:13] sc1
  v_add_u32 v5, 3584, v5
  global_load_dwordx4 v[20:23], v5, s[12:13] sc1
  v_add_u32 v5, 3584, v5
  global_load_dwordx4 v[24:27], v5, s[12:13] sc1
  v_add_u32 v5, 3584, v5
  global_load_dwordx4 v[28:31], v5, s[12:13] sc1
  v_add_u32 v5, 3584, v5
  global_load_dwordx4 v[32:35], v5, s[12:13] sc1
  v_add_u32 v5, 3584, v5
  global_load_dwordx4 v[36:39], v5, s[12:13] sc1
  v_add_u32 v5, 3584, v5
  global_load_dwordx4 v[40:43], v5, s[12:13] sc1
  v_add_u32 v5, 3584, v5
  global_load_dwordx4 v[44:47], v5, s[12:13] sc1
  v_add_u32 v5, 3584, v5
  v_lshlrev_b32 v6, 3, v0
  global_load_dwordx2 v[8:9], v6, s[8:9]
  v_cmp_le_u32 vcc, 112, v0
  v_subrev_u32 v7, 896, v6
  v_cndmask_b32 v7, v6, v7, vcc
  global_load_dwordx2 v[10:11], v7, s[10:11]
  s_waitcnt vmcnt(0)

  v_add_f32 v16, v16, v20
  v_add_f32 v17, v17, v21
  v_add_f32 v18, v18, v22
  v_add_f32 v19, v19, v23
  v_add_f32 v16, v16, v24
  v_add_f32 v17, v17, v25
  v_add_f32 v18, v18, v26
  v_add_f32 v19, v19, v27
  v_add_f32 v16, v16, v28
  v_add_f32 v17, v17, v29
  v_add_f32 v18, v18, v30
  v_add_f32 v19, v19, v31
  v_add_f32 v16, v16, v32
  v_add_f32 v17, v17, v33
  v_add_f32 v18, v18, v34
  v_add_f32 v19, v19, v35
  v_add_f32 v16, v16, v36
  v_add_f32 v17, v17, v37
  v_add_f32 v18, v18, v38
  v_add_f32 v19, v19, v39
  v_add_f32 v16, v16, v40
  v_add_f32 v17, v17, v41
  v_add_f32 v18, v18, v42
  v_add_f32 v19, v19, v43
  v_add_f32 v16, v16, v44
  v_add_f32 v17, v17, v45
  v_add_f32 v18, v18, v46
  v_add_f32 v19, v19, v47
  v_lshlrev_b32 v12, 16, v8
  v_and_b32 v13, 0xffff0000, v8
  v_lshlrev_b32 v14, 16, v9
  v_and_b32 v15, 0xffff0000, v9
  v_add_f32 v16, v16, v12
  v_add_f32 v17, v17, v13
  v_add_f32 v18, v18, v14
  v_add_f32 v19, v19, v15
  v_lshlrev_b32 v12, 16, v10
  v_and_b32 v13, 0xffff0000, v10
  v_lshlrev_b32 v14, 16, v11
  v_and_b32 v15, 0xffff0000, v11
  v_add_f32 v16, v16, v12
  v_add_f32 v17, v17, v13
  v_add_f32 v18, v18, v14
  v_add_f32 v19, v19, v15
  v_cvt_pk_bf16_f32 v16, v16, v17
  v_cvt_pk_bf16_f32 v17, v18, v19
  global_store_dwordx2 v6, v[16:17], s[26:27]
k5_end:
  s_endpgm

.section .rodata,"a"
.p2align 6
.amdhsa_kernel k1_kernel
  .amdhsa_next_free_vgpr 128
  .amdhsa_next_free_sgpr 40
  .amdhsa_accum_offset 128
  .amdhsa_group_segment_fixed_size 0
  .amdhsa_kernarg_size 112
  .amdhsa_user_sgpr_count 2
  .amdhsa_user_sgpr_kernarg_segment_ptr 1
  .amdhsa_system_sgpr_workgroup_id_x 1
.end_amdhsa_kernel
.p2align 6
.amdhsa_kernel k2_kernel
  .amdhsa_next_free_vgpr 96
  .amdhsa_next_free_sgpr 40
  .amdhsa_accum_offset 96
  .amdhsa_group_segment_fixed_size 0
  .amdhsa_kernarg_size 112
  .amdhsa_user_sgpr_count 2
  .amdhsa_user_sgpr_kernarg_segment_ptr 1
  .amdhsa_system_sgpr_workgroup_id_x 1
.end_amdhsa_kernel
.p2align 6
.amdhsa_kernel k3_kernel
  .amdhsa_next_free_vgpr 128
  .amdhsa_next_free_sgpr 40
  .amdhsa_accum_offset 128
  .amdhsa_group_segment_fixed_size 0
  .amdhsa_kernarg_size 112
  .amdhsa_user_sgpr_count 2
  .amdhsa_user_sgpr_kernarg_segment_ptr 1
  .amdhsa_system_sgpr_workgroup_id_x 1
.end_amdhsa_kernel
.p2align 6
.amdhsa_kernel k4_kernel
  .amdhsa_next_free_vgpr 128
  .amdhsa_next_free_sgpr 40
  .amdhsa_accum_offset 128
  .amdhsa_group_segment_fixed_size 0
  .amdhsa_kernarg_size 112
  .amdhsa_user_sgpr_count 2
  .amdhsa_user_sgpr_kernarg_segment_ptr 1
  .amdhsa_system_sgpr_workgroup_id_x 1
.end_amdhsa_kernel
.p2align 6
.amdhsa_kernel k5_kernel
  .amdhsa_next_free_vgpr 128
  .amdhsa_next_free_sgpr 40
  .amdhsa_accum_offset 128
  .amdhsa_group_segment_fixed_size 0
  .amdhsa_kernarg_size 112
  .amdhsa_user_sgpr_count 2
  .amdhsa_user_sgpr_kernarg_segment_ptr 1
  .amdhsa_system_sgpr_workgroup_id_x 1
.end_amdhsa_kernel
```
